```python
import torch

def _softmax(x, axis=-1):
    return torch.softmax(x, dim=axis)
def _gelu(x):
    return torch.nn.functional.gelu(x, approximate="tanh")
def _silu(x):
    return torch.nn.functional.silu(x)
def _sigmoid(x):
    return torch.sigmoid(x)
def _layernorm(x, axis=-1, eps=1e-5):
    m = x.mean(dim=axis, keepdim=True)
    v = x.var(dim=axis, keepdim=True, unbiased=False)
    return (x - m) / torch.sqrt(v + eps)
def _scatter_add(tgt, idx, src, axis=0):
    return tgt.clone().index_add_(axis, idx, src)
def _segment_sum(src, seg, n):
    out = torch.zeros((n,) + src.shape[1:], dtype=src.dtype)
    return out.index_add_(0, seg, src)
def _pad(x, pw):
    flat = tuple(v for pair in reversed(pw) for v in pair)
    return torch.nn.functional.pad(x, flat)

kernel_name = 'sequential_preLN__linear_kernel_hedgehog__glu_gated_geglu__prompt'

def setup_inputs():

    _w = (lambda a: (lambda t: t.to(torch.bfloat16) if t.is_floating_point() else t)(torch.as_tensor(a)))
    def _A_setup():
        B, S, D, H = 1, 2048, 448, 16
        Dh = D // H
        return {
            "x": _w((lambda *s: torch.randn(*s, dtype=torch.bfloat16) * 0.05)(B, S, D)),
            "wqkv": _w((lambda *s: torch.randn(*s, dtype=torch.bfloat16) * 0.2)(D, 3 * D)),
            "w_phi": _w((lambda *s: torch.randn(*s, dtype=torch.bfloat16) * 0.2)(H, Dh, Dh) * (Dh ** -0.5)),
            "wo": _w((lambda *s: torch.randn(*s, dtype=torch.bfloat16) * 0.05)(D, D)),
        }
    _A_in = _A_setup()

    def _B_setup():
        B, S, Dm, Df = 1, 2048, 448, 1792
        return {
            "x": _w((lambda *s: torch.randn(*s, dtype=torch.bfloat16) * 0.05)(B, S, Dm)),
            "w_gate": _w((lambda *s: torch.randn(*s, dtype=torch.bfloat16) * 0.4)(Dm, Df) * (Dm ** -0.5)),
            "w_up": _w((lambda *s: torch.randn(*s, dtype=torch.bfloat16) * 0.4)(Dm, Df) * (Dm ** -0.5)),
            "w_down": _w((lambda *s: torch.randn(*s, dtype=torch.bfloat16) * 0.4)(Df, Dm) * (Df ** -0.5)),
        }
    _B_in = _B_setup()

    return {
        "A_x": _A_in["x"],
        "A_wqkv": _A_in["wqkv"],
        "A_w_phi": _A_in["w_phi"],
        "A_wo": _A_in["wo"],
        "B_x": _B_in["x"],
        "B_w_gate": _B_in["w_gate"],
        "B_w_up": _B_in["w_up"],
        "B_w_down": _B_in["w_down"],
    }

def reference(A_x, A_wqkv, A_w_phi, A_wo, B_x, B_w_gate, B_w_up, B_w_down):
    def _A_ref(x, wqkv, w_phi, wo):
        B, S, D = x.shape
        H = 16; Dh = D // H
        qkv = (lambda x, *d: x.permute(*d))((x @ wqkv).reshape(B, S, 3, H, Dh), 2, 0, 3, 1, 4)
        q, k, v = qkv[0], qkv[1], qkv[2]
        pq = torch.einsum("bhsd,hdf->bhsf", q, w_phi)
        pk = torch.einsum("bhsd,hdf->bhsf", k, w_phi)
        phi_q = torch.concatenate([_softmax(pq, axis=-1), _softmax(-pq, axis=-1)], axis=-1)
        phi_k = torch.concatenate([_softmax(pk, axis=-1), _softmax(-pk, axis=-1)], axis=-1)
        kv = torch.einsum("bhsf,bhsd->bhfd", phi_k, v)
        z  = torch.einsum("bhsf->bhf", phi_k)
        num = torch.einsum("bhqf,bhfd->bhqd", phi_q, kv)
        den = torch.einsum("bhqf,bhf->bhq", phi_q, z)[..., None] + 1e-6
        o = num / den
        return (lambda x, *d: x.permute(*d))(o, 0, 2, 1, 3).reshape(B, S, D) @ wo

    def _B_ref(x, w_gate, w_up, w_down):
        g = torch.einsum("bsd,df->bsf", x, w_gate)
        u = torch.einsum("bsd,df->bsf", x, w_up)
        h = _gelu(g) * u
        return torch.einsum("bsf,fd->bsd", h, w_down)

    x = A_x
    h = x + _A_ref(_layernorm(x, axis=-1), A_wqkv, A_w_phi, A_wo)
    h2 = h + _B_ref(_layernorm(h, axis=-1), B_w_gate, B_w_up, B_w_down)
    return h2
```

```asm
; @launch grid=(256,1,1) block=(512,1,1) lds=163840
.amdgcn_target "amdgcn-amd-amdhsa--gfx950"
.text
.globl sequential_preLN__linear_kernel_hedgehog__glu_gated_geglu__prompt_kernel
.p2align 8
.type sequential_preLN__linear_kernel_hedgehog__glu_gated_geglu__prompt_kernel,@function
sequential_preLN__linear_kernel_hedgehog__glu_gated_geglu__prompt_kernel:
L_code_start:
  s_cmp_ge_u32 s2, 256
  s_cbranch_scc1 L_end
  s_setprio 3
  s_load_dwordx2 s[8:9], s[0:1], 0
  s_getpc_b64 s[4:5]
  v_lshlrev_b32 v14, 7, v0
  s_and_b32 s56, s2, 24
  s_cmp_eq_u32 s56, 0
  s_cselect_b32 s56, 0x65fc, 0
  v_min_u32 v14, s56, v14
  s_load_dwordx16 s[64:79], s[0:1], 0
  s_load_dwordx4 s[80:83], s[0:1], 64
  s_load_dwordx2 s[84:85], s[0:1], 80
  v_and_b32 v1, 63, v0
  v_lshrrev_b32 v5, 6, v0
  s_nop 0
  v_readfirstlane_b32 s50, v5
  v_lshrrev_b32 v2, 4, v1
  s_bfe_u32 s51, s2, 0x20001
  s_lshl_b32 s51, s51, 2
  s_bfe_u32 s52, s2, 0x20003
  s_add_u32 s48, s51, s52
  s_mov_b32 s10, 1835008
  s_mov_b32 s11, 0x20000
  v_lshrrev_b32 v5, 3, v1
  v_mul_u32_u24 v5, 896, v5
  v_and_b32 v6, 7, v1
  v_xor_b32 v8, v6, v2
  v_lshl_add_u32 v204, v8, 4, v5
  v_xor_b32 v8, 4, v8
  v_lshl_add_u32 v205, v8, 4, v5
  s_lshl_b32 s59, s48, 3
  s_add_u32 s59, s59, s50
  s_mul_i32 s60, s59, 14336
  s_add_u32 s61, s60, 7168
  s_mul_i32 s98, s50, 14336
  s_and_b32 s53, s2, 1
  s_lshl_b32 s54, s53, 3
  s_lshr_b32 s55, s2, 5
  s_add_u32 s49, s54, s55
  s_lshl_b32 s91, s50, 10
  v_lshrrev_b32 v5, 2, v1
  v_mul_u32_u24 v5, 2688, v5
  v_and_b32 v6, 3, v1
  v_and_b32 v7, 2, v2
  v_xor_b32 v6, v6, v7
  v_lshl_add_u32 v206, v6, 4, v5
  s_mul_i32 s89, s49, 56
  s_and_b32 s52, s49, 1
  s_lshl_b32 s52, s52, 3
  s_sub_u32 s89, s89, s52
  s_mul_i32 s62, s50, 43008
  s_add_u32 s62, s62, s89
  s_mov_b32 s14, 1204224
  s_mov_b32 s15, 0x20000
  s_mul_i32 s53, s2, 7168
  s_cmp_eq_u32 s50, 0
  s_cselect_b32 s54, 0, 2146435072
  s_add_u32 s53, s53, s54
  s_mul_i32 s55, s2, 4736
  s_cmp_eq_u32 s50, 1
  s_cselect_b32 s54, 0, 2146435072
  s_add_u32 s55, s55, s54
  v_min_u32 v9, 55, v1
  v_lshlrev_b32 v9, 7, v9
  v_min_u32 v10, 36, v1
  v_lshlrev_b32 v10, 7, v10
  s_waitcnt lgkmcnt(0)
  s_mov_b64 s[12:13], s[66:67]
  buffer_load_dword v15, v9, s[8:11], s53 offen
  buffer_load_dword v15, v10, s[12:15], s55 offen
  s_add_u32 m0, s98, 0
  s_nop 0
  buffer_load_dwordx4 v204, s[8:11], s60 offen offset:0 lds
  s_add_u32 m0, s98, 7168
  s_nop 0
  buffer_load_dwordx4 v205, s[8:11], s61 offen offset:0 lds
  s_add_u32 m0, s98, 896
  s_nop 0
  buffer_load_dwordx4 v204, s[8:11], s60 offen offset:128 lds
  s_add_u32 m0, s98, 8064
  s_nop 0
  buffer_load_dwordx4 v205, s[8:11], s61 offen offset:128 lds
  s_add_u32 m0, s98, 1792
  s_nop 0
  buffer_load_dwordx4 v204, s[8:11], s60 offen offset:256 lds
  s_add_u32 m0, s98, 8960
  s_nop 0
  buffer_load_dwordx4 v205, s[8:11], s61 offen offset:256 lds
  s_add_u32 m0, s98, 2688
  s_nop 0
  buffer_load_dwordx4 v204, s[8:11], s60 offen offset:384 lds
  s_add_u32 m0, s98, 9856
  s_nop 0
  buffer_load_dwordx4 v205, s[8:11], s61 offen offset:384 lds
  s_add_u32 m0, s98, 3584
  s_nop 0
  buffer_load_dwordx4 v204, s[8:11], s60 offen offset:512 lds
  s_add_u32 m0, s98, 10752
  s_nop 0
  buffer_load_dwordx4 v205, s[8:11], s61 offen offset:512 lds
  s_add_u32 m0, s98, 4480
  s_nop 0
  buffer_load_dwordx4 v204, s[8:11], s60 offen offset:640 lds
  s_add_u32 m0, s98, 11648
  s_nop 0
  buffer_load_dwordx4 v205, s[8:11], s61 offen offset:640 lds
  s_add_u32 m0, s98, 5376
  s_nop 0
  buffer_load_dwordx4 v204, s[8:11], s60 offen offset:768 lds
  s_add_u32 m0, s98, 12544
  s_nop 0
  buffer_load_dwordx4 v205, s[8:11], s61 offen offset:768 lds
  s_setprio 2
  global_load_dword v15, v14, s[4:5]
  s_add_u32 m0, s91, 114688
  s_add_u32 s52, s62, 896
  buffer_load_dwordx4 v206, s[12:15], s52 offen lds
  v_and_b32 v3, 15, v1
  v_lshlrev_b32 v4, 4, v1
  v_mov_b32 v12, 1
  s_and_b32 s97, s2, 7
  s_lshr_b32 s96, s2, 3
  s_and_b32 s53, s97, 1
  s_lshl_b32 s54, s53, 3
  s_lshr_b32 s55, s96, 2
  s_add_u32 s49, s54, s55
  s_lshl_b32 s93, s97, 1
  s_and_b32 s56, s96, 1
  s_add_u32 s93, s93, s56
  s_lshr_b32 s94, s96, 1
  s_mul_i32 s95, s53, 7
  s_add_u32 s95, s95, s55
  s_cmp_eq_u32 s55, 7
  s_cselect_b32 s95, 15, s95
  s_and_b32 s57, s50, 3
  s_lshr_b32 s58, s50, 2
  s_lshl_b32 s91, s50, 10
  s_mov_b64 s[12:13], s[66:67]
  s_mov_b32 s14, 1204224
  s_mov_b32 s15, 0x20000
  s_mov_b64 s[16:17], s[68:69]
  s_mov_b32 s18, 25088
  s_mov_b32 s19, 0x20000
  s_mov_b64 s[20:21], s[70:71]
  s_mov_b32 s22, 401408
  s_mov_b32 s23, 0x20000
  s_mov_b64 s[24:25], s[74:75]
  s_mov_b32 s26, 1605632
  s_mov_b32 s27, 0x20000
  s_mov_b64 s[28:29], s[76:77]
  s_mov_b32 s30, 1605632
  s_mov_b32 s31, 0x20000
  s_mov_b64 s[32:33], s[78:79]
  s_mov_b32 s34, 1605632
  s_mov_b32 s35, 0x20000
  s_mov_b64 s[36:37], s[80:81]
  s_mov_b32 s38, 1835008
  s_mov_b32 s39, 0x20000
  s_mov_b64 s[40:41], s[82:83]
  s_mov_b32 s42, 256
  s_mov_b32 s43, 0x20000
  s_mov_b64 s[44:45], s[84:85]
  s_mov_b32 s46, 268435456
  s_mov_b32 s47, 0x20000
  s_mov_b32 s92, 0x3fb8aa3b
  s_lshl_b32 s88, s49, 16
  s_add_u32 s88, s88, 1048576
  s_lshl_b32 s71, s48, 12
  s_add_u32 s71, s71, s88
  s_lshl_b32 s72, s59, 4
  s_add_u32 s72, s72, s49
  s_lshl_b32 s72, s72, 10
  s_add_u32 s72, s72, 2097152
  s_lshl_b32 s78, s95, 4
  s_add_u32 s78, s78, s48
  s_lshl_b32 s78, s78, 10
  s_add_u32 s78, s78, 65536
  s_and_b32 s76, s94, 3
  s_lshr_b32 s77, s94, 2
  s_lshl_b32 s51, s93, 2
  s_add_u32 s77, s77, s51
  s_mul_i32 s73, s77, 28
  s_lshl_b32 s52, s76, 3
  s_add_u32 s73, s73, s52
  s_lshl_b32 s73, s73, 10
  s_add_u32 s73, s73, 4194304
  s_lshl_b32 s74, s77, 2
  s_add_u32 s74, s74, s76
  s_lshl_b32 s74, s74, 9
  s_add_u32 s74, s74, 327680
  s_lshl_b32 s79, s48, 2
  s_add_u32 s79, s79, s57
  s_mul_i32 s75, s79, 114688
  s_lshl_b32 s51, s95, 13
  s_add_u32 s75, s75, s51
  s_lshl_b32 s51, s58, 11
  s_add_u32 s75, s75, s51
  s_add_u32 s75, s75, 6291456
  s_cmp_ge_u32 s95, 14
  s_cselect_b32 s51, 2146435072, 0
  s_add_u32 s75, s75, s51
  v_lshlrev_b32 v210, 3, v0
  s_cmp_ge_u32 s50, 4
  s_cselect_b32 s51, 2146435072, 0
  v_lshlrev_b32 v214, 2, v0
  v_add_u32 v214, s51, v214
  s_lshl_b32 s51, s58, 12
  s_lshl_b32 s52, s57, 7
  s_add_u32 s51, s51, s52
  s_lshl_b32 s52, s76, 1
  s_add_u32 s52, s52, s58
  s_cmp_eq_u32 s52, 7
  s_cselect_b32 s69, 2146435072, 0
  s_add_u32 s51, s51, s69
  v_lshrrev_b32 v6, 3, v1
  v_lshlrev_b32 v215, 9, v6
  v_and_b32 v5, 7, v1
  v_lshl_add_u32 v215, v5, 4, v215
  v_add_u32 v215, s51, v215
  s_cmp_ge_u32 s50, 4
  s_mov_b32 s63, 1033984
  s_cmov_b32 s63, 860160
  s_cselect_b32 s67, 10240, 0
  s_max_u32 s67, s67, 3072
  s_add_u32 s67, s67, s98
  s_add_u32 s63, s63, s62
  v_lshrrev_b32 v5, 3, v3
  v_mul_u32_u24 v5, 7168, v5
  v_add_u32 v5, s98, v5
  v_and_b32 v6, 7, v3
  v_lshl_add_u32 v5, v6, 7, v5
  v_lshrrev_b32 v6, 1, v3
  v_xor_b32 v6, v6, v2
  v_lshl_add_u32 v208, v6, 4, v5
  v_xor_b32 v209, 64, v208
  v_bfe_u32 v5, v1, 2, 2
  v_lshl_add_u32 v5, v2, 3, v5
  v_lshlrev_b32 v5, 6, v5
  v_and_b32 v6, 3, v1
  s_and_b32 s52, s49, 1
  v_add_u32 v6, s52, v6
  v_and_b32 v7, 1, v2
  v_lshlrev_b32 v7, 2, v7
  v_xor_b32 v6, v6, v7
  v_lshl_add_u32 v207, v6, 3, v5
  v_lshrrev_b32 v5, 2, v3
  v_and_b32 v6, 3, v3
  v_cmp_eq_u32 vcc, v5, v2
  s_nop 1
  v_cndmask_b32 v6, 7, v6, vcc
  v_mov_b32 v8, 0x3f80
  v_mov_b32 v9, 0x3f800000
  v_cmp_eq_u32 vcc, 0, v6
  s_nop 1
  v_cndmask_b32 v7, 0, v8, vcc
  v_cmp_eq_u32 vcc, 1, v6
  s_nop 1
  v_cndmask_b32 v116, v7, v9, vcc
  v_mov_b32 v122, v116
  v_cmp_eq_u32 vcc, 2, v6
  s_nop 1
  v_cndmask_b32 v7, 0, v8, vcc
  v_cmp_eq_u32 vcc, 3, v6
  s_nop 1
  v_cndmask_b32 v117, v7, v9, vcc
  v_mov_b32 v123, v117
  v_mov_b32 v118, 0
  v_mov_b32 v119, 0
  v_mov_b32 v120, 0
  v_mov_b32 v121, 0
  v_mov_b32 v124, 0
  v_mov_b32 v125, 0
  v_mov_b32 v126, 0
  v_mov_b32 v127, 0
  v_mov_b32 v128, 0
  v_mov_b32 v129, 0
  v_mov_b32 v130, 0
  v_mov_b32 v131, 0
  v_mov_b32 v10, 0x3f803f80
  v_lshlrev_b32 v5, 2, v1
  v_add_u32 v5, 162816, v5
  ds_write_b32 v5, v124
  s_add_u32 m0, s91, 122880
  s_add_u32 s52, s62, 344960
  buffer_load_dwordx4 v206, s[12:15], s52 offen lds
  s_add_u32 m0, s91, 131072
  s_add_u32 s52, s62, 689024
  buffer_load_dwordx4 v206, s[12:15], s52 offen lds
  s_waitcnt vmcnt(16)
  ds_read_b128 v[16:19], v208 offset:0
  ds_read_b128 v[20:23], v209 offset:0
  s_waitcnt lgkmcnt(0)
  v_dot2_f32_bf16 v124, v16, v10, v124
  v_dot2_f32_bf16 v128, v16, v16, v128
  v_dot2_f32_bf16 v125, v17, v10, v125
  v_dot2_f32_bf16 v129, v17, v17, v129
  v_dot2_f32_bf16 v126, v18, v10, v126
  v_dot2_f32_bf16 v130, v18, v18, v130
  v_dot2_f32_bf16 v127, v19, v10, v127
  v_dot2_f32_bf16 v131, v19, v19, v131
  v_dot2_f32_bf16 v124, v20, v10, v124
  v_dot2_f32_bf16 v128, v20, v20, v128
  v_dot2_f32_bf16 v125, v21, v10, v125
  v_dot2_f32_bf16 v129, v21, v21, v129
  v_dot2_f32_bf16 v126, v22, v10, v126
  v_dot2_f32_bf16 v130, v22, v22, v130
  v_dot2_f32_bf16 v127, v23, v10, v127
  v_dot2_f32_bf16 v131, v23, v23, v131
  s_waitcnt vmcnt(14)
  ds_read_b128 v[24:27], v208 offset:1024
  ds_read_b128 v[28:31], v209 offset:1024
  s_lshl_b32 s51, s2, 3
  s_add_u32 s51, s51, s50
  s_cmp_lg_u32 s51, 7
  s_cbranch_scc1 L_init_1
  v_lshlrev_b32 v5, 8, v1
  v_mov_b32 v6, 0
  buffer_store_dword v6, v5, s[44:47], 0 offen sc1
L_init_1:
  v_mov_b32 v216, -1
  v_mov_b32 v217, -1
  v_mov_b32 v218, -1
  v_mov_b32 v219, -1
  buffer_store_dwordx2 v[216:217], v210, s[44:47], s71 offen sc1
  buffer_store_dwordx4 v[216:219], v4, s[44:47], s72 offen sc1
  s_waitcnt lgkmcnt(0)
  v_dot2_f32_bf16 v124, v24, v10, v124
  v_dot2_f32_bf16 v128, v24, v24, v128
  v_dot2_f32_bf16 v125, v25, v10, v125
  v_dot2_f32_bf16 v129, v25, v25, v129
  v_dot2_f32_bf16 v126, v26, v10, v126
  v_dot2_f32_bf16 v130, v26, v26, v130
  v_dot2_f32_bf16 v127, v27, v10, v127
  v_dot2_f32_bf16 v131, v27, v27, v131
  v_dot2_f32_bf16 v124, v28, v10, v124
  v_dot2_f32_bf16 v128, v28, v28, v128
  v_dot2_f32_bf16 v125, v29, v10, v125
  v_dot2_f32_bf16 v129, v29, v29, v129
  v_dot2_f32_bf16 v126, v30, v10, v126
  v_dot2_f32_bf16 v130, v30, v30, v130
  v_dot2_f32_bf16 v127, v31, v10, v127
  v_dot2_f32_bf16 v131, v31, v31, v131
  s_waitcnt vmcnt(14)
  ds_read_b128 v[32:35], v208 offset:2048
  ds_read_b128 v[36:39], v209 offset:2048
  s_waitcnt lgkmcnt(0)
  v_dot2_f32_bf16 v124, v32, v10, v124
  v_dot2_f32_bf16 v128, v32, v32, v128
  v_dot2_f32_bf16 v125, v33, v10, v125
  v_dot2_f32_bf16 v129, v33, v33, v129
  v_dot2_f32_bf16 v126, v34, v10, v126
  v_dot2_f32_bf16 v130, v34, v34, v130
  v_dot2_f32_bf16 v127, v35, v10, v127
  v_dot2_f32_bf16 v131, v35, v35, v131
  v_dot2_f32_bf16 v124, v36, v10, v124
  v_dot2_f32_bf16 v128, v36, v36, v128
  v_dot2_f32_bf16 v125, v37, v10, v125
  v_dot2_f32_bf16 v129, v37, v37, v129
  v_dot2_f32_bf16 v126, v38, v10, v126
  v_dot2_f32_bf16 v130, v38, v38, v130
  v_dot2_f32_bf16 v127, v39, v10, v127
  v_dot2_f32_bf16 v131, v39, v39, v131
  s_waitcnt vmcnt(12)
  ds_read_b128 v[40:43], v208 offset:3072
  ds_read_b128 v[44:47], v209 offset:3072
  s_cmp_ge_u32 s50, 4
  s_cselect_b32 s51, 2146435072, 0
  s_add_u32 s51, s51, s62
  s_add_u32 m0, s91, 139264
  s_add_u32 s52, s51, 1033088
  buffer_load_dwordx4 v206, s[12:15], s52 offen lds
  v_lshlrev_b32 v5, 4, v0
  v_mov_b32 v6, 2146435072
  v_cmp_gt_u32 vcc, 98, v0
  s_nop 1
  v_cndmask_b32 v5, v6, v5, vcc
  s_min_u32 s51, s91, 2048
  s_add_u32 m0, s51, 151552
  s_mul_i32 s51, s49, 1568
  buffer_load_dwordx4 v5, s[16:19], s51 offen lds
  s_waitcnt lgkmcnt(0)
  v_dot2_f32_bf16 v124, v40, v10, v124
  v_dot2_f32_bf16 v128, v40, v40, v128
  v_dot2_f32_bf16 v125, v41, v10, v125
  v_dot2_f32_bf16 v129, v41, v41, v129
  v_dot2_f32_bf16 v126, v42, v10, v126
  v_dot2_f32_bf16 v130, v42, v42, v130
  v_dot2_f32_bf16 v127, v43, v10, v127
  v_dot2_f32_bf16 v131, v43, v43, v131
  v_dot2_f32_bf16 v124, v44, v10, v124
  v_dot2_f32_bf16 v128, v44, v44, v128
  v_dot2_f32_bf16 v125, v45, v10, v125
  v_dot2_f32_bf16 v129, v45, v45, v129
  v_dot2_f32_bf16 v126, v46, v10, v126
  v_dot2_f32_bf16 v130, v46, v46, v130
  v_dot2_f32_bf16 v127, v47, v10, v127
  v_dot2_f32_bf16 v131, v47, v47, v131
  s_waitcnt vmcnt(12)
  ds_read_b128 v[48:51], v208 offset:4096
  ds_read_b128 v[52:55], v209 offset:4096
  s_waitcnt lgkmcnt(0)
  v_dot2_f32_bf16 v124, v48, v10, v124
  v_dot2_f32_bf16 v128, v48, v48, v128
  v_dot2_f32_bf16 v125, v49, v10, v125
  v_dot2_f32_bf16 v129, v49, v49, v129
  v_dot2_f32_bf16 v126, v50, v10, v126
  v_dot2_f32_bf16 v130, v50, v50, v130
  v_dot2_f32_bf16 v127, v51, v10, v127
  v_dot2_f32_bf16 v131, v51, v51, v131
  v_dot2_f32_bf16 v124, v52, v10, v124
  v_dot2_f32_bf16 v128, v52, v52, v128
  v_dot2_f32_bf16 v125, v53, v10, v125
  v_dot2_f32_bf16 v129, v53, v53, v129
  v_dot2_f32_bf16 v126, v54, v10, v126
  v_dot2_f32_bf16 v130, v54, v54, v130
  v_dot2_f32_bf16 v127, v55, v10, v127
  v_dot2_f32_bf16 v131, v55, v55, v131
  s_waitcnt vmcnt(10)
  ds_read_b128 v[56:59], v208 offset:5120
  ds_read_b128 v[60:63], v209 offset:5120
  s_add_u32 m0, s98, 0
  s_add_u32 s52, s62, 1792
  buffer_load_dwordx4 v206, s[12:15], s52 offen lds
  s_waitcnt lgkmcnt(0)
  v_dot2_f32_bf16 v124, v56, v10, v124
  v_dot2_f32_bf16 v128, v56, v56, v128
  v_dot2_f32_bf16 v125, v57, v10, v125
  v_dot2_f32_bf16 v129, v57, v57, v129
  v_dot2_f32_bf16 v126, v58, v10, v126
  v_dot2_f32_bf16 v130, v58, v58, v130
  v_dot2_f32_bf16 v127, v59, v10, v127
  v_dot2_f32_bf16 v131, v59, v59, v131
  v_dot2_f32_bf16 v124, v60, v10, v124
  v_dot2_f32_bf16 v128, v60, v60, v128
  v_dot2_f32_bf16 v125, v61, v10, v125
  v_dot2_f32_bf16 v129, v61, v61, v129
  v_dot2_f32_bf16 v126, v62, v10, v126
  v_dot2_f32_bf16 v130, v62, v62, v130
  v_dot2_f32_bf16 v127, v63, v10, v127
  v_dot2_f32_bf16 v131, v63, v63, v131
  s_waitcnt vmcnt(9)
  ds_read_b128 v[64:67], v208 offset:6144
  ds_read_b128 v[68:71], v209 offset:6144
  s_waitcnt lgkmcnt(0)
  v_dot2_f32_bf16 v124, v64, v10, v124
  v_dot2_f32_bf16 v128, v64, v64, v128
  v_dot2_f32_bf16 v125, v65, v10, v125
  v_dot2_f32_bf16 v129, v65, v65, v129
  v_dot2_f32_bf16 v126, v66, v10, v126
  v_dot2_f32_bf16 v130, v66, v66, v130
  v_dot2_f32_bf16 v127, v67, v10, v127
  v_dot2_f32_bf16 v131, v67, v67, v131
  v_dot2_f32_bf16 v124, v68, v10, v124
  v_dot2_f32_bf16 v128, v68, v68, v128
  v_dot2_f32_bf16 v125, v69, v10, v125
  v_dot2_f32_bf16 v129, v69, v69, v129
  v_dot2_f32_bf16 v126, v70, v10, v126
  v_dot2_f32_bf16 v130, v70, v70, v130
  v_dot2_f32_bf16 v127, v71, v10, v127
  v_dot2_f32_bf16 v131, v71, v71, v131
  s_setprio 1
  v_add_f32 v124, v124, v125
  v_add_f32 v126, v126, v127
  v_add_f32 v128, v128, v129
  v_add_f32 v130, v130, v131
  v_add_f32 v124, v124, v126
  v_add_f32 v128, v128, v130
  v_mov_b32 v125, v124
  v_mov_b32 v129, v128
  s_nop 0
  v_permlane16_swap_b32 v124, v125
  v_permlane16_swap_b32 v128, v129
  v_add_f32 v124, v124, v125
  v_add_f32 v128, v128, v129
  v_mov_b32 v125, v124
  v_mov_b32 v129, v128
  s_nop 0
  v_permlane32_swap_b32 v124, v125
  v_permlane32_swap_b32 v128, v129
  v_add_f32 v124, v124, v125
  v_add_f32 v128, v128, v129
  v_mul_f32 v124, 0x3b124925, v124
  v_mul_f32 v128, 0x3b124925, v128
  v_fma_f32 v128, -v124, v124, v128
  v_max_f32 v128, 0, v128
  v_add_f32 v128, 0x3727c5ac, v128
  v_rsq_f32 v132, v128
  s_nop 0
  v_mul_f32 v134, v124, v132
  v_sub_f32 v134, 0, v134
  v_mov_b32 v133, v132
  v_mov_b32 v135, v134
  v_lshlrev_b32 v140, 16, v16
  v_and_b32 v141, 0xffff0000, v16
  v_lshlrev_b32 v142, 16, v17
  v_and_b32 v143, 0xffff0000, v17
  v_lshlrev_b32 v144, 16, v18
  v_and_b32 v145, 0xffff0000, v18
  v_lshlrev_b32 v146, 16, v19
  v_and_b32 v147, 0xffff0000, v19
  v_lshlrev_b32 v148, 16, v20
  v_and_b32 v149, 0xffff0000, v20
  v_lshlrev_b32 v150, 16, v21
  v_and_b32 v151, 0xffff0000, v21
  v_lshlrev_b32 v152, 16, v22
  v_and_b32 v153, 0xffff0000, v22
  v_lshlrev_b32 v154, 16, v23
  v_and_b32 v155, 0xffff0000, v23
  v_pk_fma_f32 v[140:141], v[140:141], v[132:133], v[134:135]
  v_pk_fma_f32 v[142:143], v[142:143], v[132:133], v[134:135]
  v_pk_fma_f32 v[144:145], v[144:145], v[132:133], v[134:135]
  v_pk_fma_f32 v[146:147], v[146:147], v[132:133], v[134:135]
  v_pk_fma_f32 v[148:149], v[148:149], v[132:133], v[134:135]
  v_pk_fma_f32 v[150:151], v[150:151], v[132:133], v[134:135]
  v_pk_fma_f32 v[152:153], v[152:153], v[132:133], v[134:135]
  v_pk_fma_f32 v[154:155], v[154:155], v[132:133], v[134:135]
  v_cvt_pk_bf16_f32 v16, v140, v141
  v_cvt_pk_bf16_f32 v17, v142, v143
  v_cvt_pk_bf16_f32 v18, v144, v145
  v_cvt_pk_bf16_f32 v19, v146, v147
  v_cvt_pk_bf16_f32 v20, v148, v149
  v_cvt_pk_bf16_f32 v21, v150, v151
  v_cvt_pk_bf16_f32 v22, v152, v153
  v_cvt_pk_bf16_f32 v23, v154, v155
  s_add_u32 m0, s98, 1024
  s_add_u32 s52, s62, 345856
  buffer_load_dwordx4 v206, s[12:15], s52 offen lds
  v_lshlrev_b32 v140, 16, v24
  v_and_b32 v141, 0xffff0000, v24
  v_lshlrev_b32 v142, 16, v25
  v_and_b32 v143, 0xffff0000, v25
  v_lshlrev_b32 v144, 16, v26
  v_and_b32 v145, 0xffff0000, v26
  v_lshlrev_b32 v146, 16, v27
  v_and_b32 v147, 0xffff0000, v27
  v_lshlrev_b32 v148, 16, v28
  v_and_b32 v149, 0xffff0000, v28
  v_lshlrev_b32 v150, 16, v29
  v_and_b32 v151, 0xffff0000, v29
  v_lshlrev_b32 v152, 16, v30
  v_and_b32 v153, 0xffff0000, v30
  v_lshlrev_b32 v154, 16, v31
  v_and_b32 v155, 0xffff0000, v31
  v_pk_fma_f32 v[140:141], v[140:141], v[132:133], v[134:135]
  v_pk_fma_f32 v[142:143], v[142:143], v[132:133], v[134:135]
  v_pk_fma_f32 v[144:145], v[144:145], v[132:133], v[134:135]
  v_pk_fma_f32 v[146:147], v[146:147], v[132:133], v[134:135]
  v_pk_fma_f32 v[148:149], v[148:149], v[132:133], v[134:135]
  v_pk_fma_f32 v[150:151], v[150:151], v[132:133], v[134:135]
  v_pk_fma_f32 v[152:153], v[152:153], v[132:133], v[134:135]
  v_pk_fma_f32 v[154:155], v[154:155], v[132:133], v[134:135]
  v_cvt_pk_bf16_f32 v24, v140, v141
  v_cvt_pk_bf16_f32 v25, v142, v143
  v_cvt_pk_bf16_f32 v26, v144, v145
  v_cvt_pk_bf16_f32 v27, v146, v147
  v_cvt_pk_bf16_f32 v28, v148, v149
  v_cvt_pk_bf16_f32 v29, v150, v151
  v_cvt_pk_bf16_f32 v30, v152, v153
  v_cvt_pk_bf16_f32 v31, v154, v155
  s_add_u32 m0, s98, 2048
  s_add_u32 s52, s62, 689920
  buffer_load_dwordx4 v206, s[12:15], s52 offen lds
  v_lshlrev_b32 v140, 16, v32
  v_and_b32 v141, 0xffff0000, v32
  v_lshlrev_b32 v142, 16, v33
  v_and_b32 v143, 0xffff0000, v33
  v_lshlrev_b32 v144, 16, v34
  v_and_b32 v145, 0xffff0000, v34
  v_lshlrev_b32 v146, 16, v35
  v_and_b32 v147, 0xffff0000, v35
  v_lshlrev_b32 v148, 16, v36
  v_and_b32 v149, 0xffff0000, v36
  v_lshlrev_b32 v150, 16, v37
  v_and_b32 v151, 0xffff0000, v37
  v_lshlrev_b32 v152, 16, v38
  v_and_b32 v153, 0xffff0000, v38
  v_lshlrev_b32 v154, 16, v39
  v_and_b32 v155, 0xffff0000, v39
  v_pk_fma_f32 v[140:141], v[140:141], v[132:133], v[134:135]
  v_pk_fma_f32 v[142:143], v[142:143], v[132:133], v[134:135]
  v_pk_fma_f32 v[144:145], v[144:145], v[132:133], v[134:135]
  v_pk_fma_f32 v[146:147], v[146:147], v[132:133], v[134:135]
  v_pk_fma_f32 v[148:149], v[148:149], v[132:133], v[134:135]
  v_pk_fma_f32 v[150:151], v[150:151], v[132:133], v[134:135]
  v_pk_fma_f32 v[152:153], v[152:153], v[132:133], v[134:135]
  v_pk_fma_f32 v[154:155], v[154:155], v[132:133], v[134:135]
  v_cvt_pk_bf16_f32 v32, v140, v141
  v_cvt_pk_bf16_f32 v33, v142, v143
  v_cvt_pk_bf16_f32 v34, v144, v145
  v_cvt_pk_bf16_f32 v35, v146, v147
  v_cvt_pk_bf16_f32 v36, v148, v149
  v_cvt_pk_bf16_f32 v37, v150, v151
  v_cvt_pk_bf16_f32 v38, v152, v153
  v_cvt_pk_bf16_f32 v39, v154, v155
  s_mov_b32 m0, s67
  s_nop 0
  buffer_load_dwordx4 v206, s[12:15], s63 offen lds
  v_lshlrev_b32 v140, 16, v40
  v_and_b32 v141, 0xffff0000, v40
  v_lshlrev_b32 v142, 16, v41
  v_and_b32 v143, 0xffff0000, v41
  v_lshlrev_b32 v144, 16, v42
  v_and_b32 v145, 0xffff0000, v42
  v_lshlrev_b32 v146, 16, v43
  v_and_b32 v147, 0xffff0000, v43
  v_lshlrev_b32 v148, 16, v44
  v_and_b32 v149, 0xffff0000, v44
  v_lshlrev_b32 v150, 16, v45
  v_and_b32 v151, 0xffff0000, v45
  v_lshlrev_b32 v152, 16, v46
  v_and_b32 v153, 0xffff0000, v46
  v_lshlrev_b32 v154, 16, v47
  v_and_b32 v155, 0xffff0000, v47
  v_pk_fma_f32 v[140:141], v[140:141], v[132:133], v[134:135]
  v_pk_fma_f32 v[142:143], v[142:143], v[132:133], v[134:135]
  v_pk_fma_f32 v[144:145], v[144:145], v[132:133], v[134:135]
  v_pk_fma_f32 v[146:147], v[146:147], v[132:133], v[134:135]
  v_pk_fma_f32 v[148:149], v[148:149], v[132:133], v[134:135]
  v_pk_fma_f32 v[150:151], v[150:151], v[132:133], v[134:135]
  v_pk_fma_f32 v[152:153], v[152:153], v[132:133], v[134:135]
  v_pk_fma_f32 v[154:155], v[154:155], v[132:133], v[134:135]
  v_cvt_pk_bf16_f32 v40, v140, v141
  v_cvt_pk_bf16_f32 v41, v142, v143
  v_cvt_pk_bf16_f32 v42, v144, v145
  v_cvt_pk_bf16_f32 v43, v146, v147
  v_cvt_pk_bf16_f32 v44, v148, v149
  v_cvt_pk_bf16_f32 v45, v150, v151
  v_cvt_pk_bf16_f32 v46, v152, v153
  v_cvt_pk_bf16_f32 v47, v154, v155
  v_lshlrev_b32 v140, 16, v48
  v_and_b32 v141, 0xffff0000, v48
  v_lshlrev_b32 v142, 16, v49
  v_and_b32 v143, 0xffff0000, v49
  v_lshlrev_b32 v144, 16, v50
  v_and_b32 v145, 0xffff0000, v50
  v_lshlrev_b32 v146, 16, v51
  v_and_b32 v147, 0xffff0000, v51
  v_lshlrev_b32 v148, 16, v52
  v_and_b32 v149, 0xffff0000, v52
  v_lshlrev_b32 v150, 16, v53
  v_and_b32 v151, 0xffff0000, v53
  v_lshlrev_b32 v152, 16, v54
  v_and_b32 v153, 0xffff0000, v54
  v_lshlrev_b32 v154, 16, v55
  v_and_b32 v155, 0xffff0000, v55
  v_pk_fma_f32 v[140:141], v[140:141], v[132:133], v[134:135]
  v_pk_fma_f32 v[142:143], v[142:143], v[132:133], v[134:135]
  v_pk_fma_f32 v[144:145], v[144:145], v[132:133], v[134:135]
  v_pk_fma_f32 v[146:147], v[146:147], v[132:133], v[134:135]
  v_pk_fma_f32 v[148:149], v[148:149], v[132:133], v[134:135]
  v_pk_fma_f32 v[150:151], v[150:151], v[132:133], v[134:135]
  v_pk_fma_f32 v[152:153], v[152:153], v[132:133], v[134:135]
  v_pk_fma_f32 v[154:155], v[154:155], v[132:133], v[134:135]
  v_cvt_pk_bf16_f32 v48, v140, v141
  v_cvt_pk_bf16_f32 v49, v142, v143
  v_cvt_pk_bf16_f32 v50, v144, v145
  v_cvt_pk_bf16_f32 v51, v146, v147
  v_cvt_pk_bf16_f32 v52, v148, v149
  v_cvt_pk_bf16_f32 v53, v150, v151
  v_cvt_pk_bf16_f32 v54, v152, v153
  v_cvt_pk_bf16_f32 v55, v154, v155
  v_lshlrev_b32 v140, 16, v56
  v_and_b32 v141, 0xffff0000, v56
  v_lshlrev_b32 v142, 16, v57
  v_and_b32 v143, 0xffff0000, v57
  v_lshlrev_b32 v144, 16, v58
  v_and_b32 v145, 0xffff0000, v58
  v_lshlrev_b32 v146, 16, v59
  v_and_b32 v147, 0xffff0000, v59
  v_lshlrev_b32 v148, 16, v60
  v_and_b32 v149, 0xffff0000, v60
  v_lshlrev_b32 v150, 16, v61
  v_and_b32 v151, 0xffff0000, v61
  v_lshlrev_b32 v152, 16, v62
  v_and_b32 v153, 0xffff0000, v62
  v_lshlrev_b32 v154, 16, v63
  v_and_b32 v155, 0xffff0000, v63
  v_pk_fma_f32 v[140:141], v[140:141], v[132:133], v[134:135]
  v_pk_fma_f32 v[142:143], v[142:143], v[132:133], v[134:135]
  v_pk_fma_f32 v[144:145], v[144:145], v[132:133], v[134:135]
  v_pk_fma_f32 v[146:147], v[146:147], v[132:133], v[134:135]
  v_pk_fma_f32 v[148:149], v[148:149], v[132:133], v[134:135]
  v_pk_fma_f32 v[150:151], v[150:151], v[132:133], v[134:135]
  v_pk_fma_f32 v[152:153], v[152:153], v[132:133], v[134:135]
  v_pk_fma_f32 v[154:155], v[154:155], v[132:133], v[134:135]
  v_cvt_pk_bf16_f32 v56, v140, v141
  v_cvt_pk_bf16_f32 v57, v142, v143
  v_cvt_pk_bf16_f32 v58, v144, v145
  v_cvt_pk_bf16_f32 v59, v146, v147
  v_cvt_pk_bf16_f32 v60, v148, v149
  v_cvt_pk_bf16_f32 v61, v150, v151
  v_cvt_pk_bf16_f32 v62, v152, v153
  v_cvt_pk_bf16_f32 v63, v154, v155
  v_lshlrev_b32 v140, 16, v64
  v_and_b32 v141, 0xffff0000, v64
  v_lshlrev_b32 v142, 16, v65
  v_and_b32 v143, 0xffff0000, v65
  v_lshlrev_b32 v144, 16, v66
  v_and_b32 v145, 0xffff0000, v66
  v_lshlrev_b32 v146, 16, v67
  v_and_b32 v147, 0xffff0000, v67
  v_lshlrev_b32 v148, 16, v68
  v_and_b32 v149, 0xffff0000, v68
  v_lshlrev_b32 v150, 16, v69
  v_and_b32 v151, 0xffff0000, v69
  v_lshlrev_b32 v152, 16, v70
  v_and_b32 v153, 0xffff0000, v70
  v_lshlrev_b32 v154, 16, v71
  v_and_b32 v155, 0xffff0000, v71
  v_pk_fma_f32 v[140:141], v[140:141], v[132:133], v[134:135]
  v_pk_fma_f32 v[142:143], v[142:143], v[132:133], v[134:135]
  v_pk_fma_f32 v[144:145], v[144:145], v[132:133], v[134:135]
  v_pk_fma_f32 v[146:147], v[146:147], v[132:133], v[134:135]
  v_pk_fma_f32 v[148:149], v[148:149], v[132:133], v[134:135]
  v_pk_fma_f32 v[150:151], v[150:151], v[132:133], v[134:135]
  v_pk_fma_f32 v[152:153], v[152:153], v[132:133], v[134:135]
  v_pk_fma_f32 v[154:155], v[154:155], v[132:133], v[134:135]
  v_cvt_pk_bf16_f32 v64, v140, v141
  v_cvt_pk_bf16_f32 v65, v142, v143
  v_cvt_pk_bf16_f32 v66, v144, v145
  v_cvt_pk_bf16_f32 v67, v146, v147
  v_cvt_pk_bf16_f32 v68, v148, v149
  v_cvt_pk_bf16_f32 v69, v150, v151
  v_cvt_pk_bf16_f32 v70, v152, v153
  v_cvt_pk_bf16_f32 v71, v154, v155
  s_setprio 0
  v_mul_u32_u24 v5, 224, v2
  v_add_u32 v5, 151552, v5
  v_lshl_add_u32 v172, v3, 1, v5
  v_lshrrev_b32 v7, 2, v3
  v_sub_u32 v7, v3, v7
  v_lshl_add_u32 v7, v7, 1, v5
  v_add_u32 v173, 32, v7
  v_mov_b32 v6, 153152
  v_and_b32 v7, 3, v3
  v_cmp_eq_u32 vcc, 3, v7
  s_nop 1
  v_cndmask_b32 v173, v173, v6, vcc
  v_cmp_eq_u32 vcc, 3, v2
  s_nop 1
  v_cndmask_b32 v174, v172, v6, vcc
  v_cndmask_b32 v175, v173, v6, vcc
  v_add_u32 v211, 114688, v207
  v_xor_b32 v212, 32, v211
  buffer_store_dword v216, v214, s[44:47], s78 offen sc1
  s_add_u32 s68, s73, s91
  s_add_u32 s68, s68, s69
  buffer_store_dwordx4 v[216:219], v4, s[44:47], s68 offen sc1
  s_lshl_b32 s68, s50, 6
  v_lshlrev_b32 v220, 3, v1
  v_add_u32 v220, s68, v220
  v_mov_b32 v221, 2146435072
  v_cmp_gt_u32 vcc, 8, v1
  s_nop 1
  v_cndmask_b32 v220, v221, v220, vcc
  buffer_store_dwordx2 v[216:217], v220, s[44:47], s74 offen sc1
  s_and_b32 s51, s50, 1
  s_cmp_eq_u32 s51, 1
  s_cselect_b32 s4, s28, s24
  s_cselect_b32 s5, s29, s25
  s_mov_b32 s6, 1605632
  s_mov_b32 s7, 0x20000
  s_lshl_b32 s51, s48, 2
  s_lshr_b32 s52, s50, 1
  s_add_u32 s51, s51, s52
  s_mul_i32 s51, s51, 25088
  s_lshl_b32 s52, s95, 8
  s_add_u32 s51, s51, s52
  s_cmp_ge_u32 s95, 14
  s_cselect_b32 s52, 2146435072, 0
  v_lshlrev_b32 v204, 2, v1
  v_add_u32 v204, s52, v204
  buffer_load_dword v248, v204, s[4:7], s51 offen
  s_add_u32 s51, s51, 3584
  buffer_load_dword v249, v204, s[4:7], s51 offen
  s_add_u32 s51, s51, 3584
  buffer_load_dword v250, v204, s[4:7], s51 offen
  s_add_u32 s51, s51, 3584
  buffer_load_dword v251, v204, s[4:7], s51 offen
  s_add_u32 s51, s51, 3584
  buffer_load_dword v252, v204, s[4:7], s51 offen
  s_add_u32 s51, s51, 3584
  buffer_load_dword v253, v204, s[4:7], s51 offen
  s_add_u32 s51, s51, 3584
  buffer_load_dword v254, v204, s[4:7], s51 offen
  s_waitcnt vmcnt(14)
  s_waitcnt lgkmcnt(0)
  s_barrier
  s_cmp_lg_u32 s50, 5
  s_cbranch_scc1 L_is_2
  s_mov_b64 exec, 1
  s_and_b32 s51, s2, 15
  s_lshl_b32 s51, s51, 4
  v_mov_b32 v13, s51
  buffer_atomic_add v12, v13, s[40:43], 0 offen sc1
  s_mov_b64 exec, -1
L_is_2:
  ds_read_u16 v100, v172 offset:0
  ds_read_u16 v108, v172 offset:56
  ds_read_u16 v101, v172 offset:112
  ds_read_u16 v109, v172 offset:168
  ds_read_u16 v102, v174 offset:896
  ds_read_u16 v110, v174 offset:952
  ds_read_u16 v103, v174 offset:1008
  ds_read_u16 v111, v174 offset:1064
  ds_read_u16 v104, v173 offset:0
  ds_read_u16 v112, v173 offset:56
  ds_read_u16 v105, v173 offset:112
  ds_read_u16 v113, v173 offset:168
  ds_read_u16 v106, v175 offset:896
  ds_read_u16 v114, v175 offset:952
  ds_read_u16 v107, v175 offset:1008
  ds_read_u16 v115, v175 offset:1064
  v_lshrrev_b32 v213, 3, v1
  v_mul_u32_u24 v213, 896, v213
  v_and_b32 v6, 7, v1
  v_lshlrev_b32 v7, 1, v2
  v_xor_b32 v6, v6, v7
  v_lshl_add_u32 v213, v6, 4, v213
  s_lshl_b32 s70, s76, 1
  s_add_u32 s70, s70, s58
  s_cmp_eq_u32 s70, 7
  s_cselect_b32 s52, 2146435072, 0
  s_lshl_b32 s70, s70, 7
  s_add_u32 s70, s70, s52
  s_mul_i32 s52, s57, 100352
  s_add_u32 s70, s70, s52
  ds_read_b64_tr_b16 v[140:141], v211 offset:0
  ds_read_b64_tr_b16 v[142:143], v211 offset:256
  ds_read_b64_tr_b16 v[144:145], v212 offset:0
  ds_read_b64_tr_b16 v[146:147], v212 offset:256
  ds_read_b64_tr_b16 v[148:149], v211 offset:2048
  ds_read_b64_tr_b16 v[150:151], v211 offset:2304
  ds_read_b64_tr_b16 v[152:153], v212 offset:2048
  ds_read_b64_tr_b16 v[154:155], v212 offset:2304
  ds_read_b64_tr_b16 v[156:157], v211 offset:4096
  ds_read_b64_tr_b16 v[158:159], v211 offset:4352
  ds_read_b64_tr_b16 v[160:161], v212 offset:4096
  ds_read_b64_tr_b16 v[162:163], v212 offset:4352
  ds_read_b64_tr_b16 v[164:165], v211 offset:6144
  ds_read_b64_tr_b16 v[166:167], v211 offset:6400
  ds_read_b64_tr_b16 v[168:169], v212 offset:6144
  ds_read_b64_tr_b16 v[170:171], v212 offset:6400
  s_waitcnt lgkmcnt(12)
  v_mfma_f32_16x16x32_bf16 v[124:127], v[140:143], v[16:19], 0
  v_mfma_f32_16x16x32_bf16 v[128:131], v[144:147], v[16:19], 0
  ds_read_b64_tr_b16 v[140:141], v211 offset:8192
  ds_read_b64_tr_b16 v[142:143], v211 offset:8448
  ds_read_b64_tr_b16 v[144:145], v212 offset:8192
  ds_read_b64_tr_b16 v[146:147], v212 offset:8448
  s_waitcnt lgkmcnt(12)
  v_mfma_f32_16x16x32_bf16 v[124:127], v[148:151], v[20:23], v[124:127]
  v_mfma_f32_16x16x32_bf16 v[128:131], v[152:155], v[20:23], v[128:131]
  ds_read_b64_tr_b16 v[148:149], v211 offset:10240
  ds_read_b64_tr_b16 v[150:151], v211 offset:10496
  ds_read_b64_tr_b16 v[152:153], v212 offset:10240
  ds_read_b64_tr_b16 v[154:155], v212 offset:10496
  s_waitcnt lgkmcnt(12)
  v_mfma_f32_16x16x32_bf16 v[124:127], v[156:159], v[24:27], v[124:127]
  v_mfma_f32_16x16x32_bf16 v[128:131], v[160:163], v[24:27], v[128:131]
  s_add_u32 m0, s98, 11264
  s_add_u32 s52, s62, 0
  buffer_load_dwordx4 v206, s[12:15], s52 offen lds
  ds_read_b64_tr_b16 v[156:157], v211 offset:12288
  ds_read_b64_tr_b16 v[158:159], v211 offset:12544
  ds_read_b64_tr_b16 v[160:161], v212 offset:12288
  ds_read_b64_tr_b16 v[162:163], v212 offset:12544
  s_waitcnt lgkmcnt(12)
  v_mfma_f32_16x16x32_bf16 v[124:127], v[164:167], v[28:31], v[124:127]
  v_mfma_f32_16x16x32_bf16 v[128:131], v[168:171], v[28:31], v[128:131]
  ds_read_b64_tr_b16 v[164:165], v211 offset:14336
  ds_read_b64_tr_b16 v[166:167], v211 offset:14592
  ds_read_b64_tr_b16 v[168:169], v212 offset:14336
  ds_read_b64_tr_b16 v[170:171], v212 offset:14592
  s_waitcnt lgkmcnt(12)
  v_mfma_f32_16x16x32_bf16 v[124:127], v[140:143], v[32:35], v[124:127]
  v_mfma_f32_16x16x32_bf16 v[128:131], v[144:147], v[32:35], v[128:131]
  ds_read_b64_tr_b16 v[140:141], v211 offset:16384
  ds_read_b64_tr_b16 v[142:143], v211 offset:16640
  ds_read_b64_tr_b16 v[144:145], v212 offset:16384
  ds_read_b64_tr_b16 v[146:147], v212 offset:16640
  s_waitcnt lgkmcnt(12)
  v_mfma_f32_16x16x32_bf16 v[124:127], v[148:151], v[36:39], v[124:127]
  v_mfma_f32_16x16x32_bf16 v[128:131], v[152:155], v[36:39], v[128:131]
  ds_read_b64_tr_b16 v[148:149], v211 offset:18432
  ds_read_b64_tr_b16 v[150:151], v211 offset:18688
  ds_read_b64_tr_b16 v[152:153], v212 offset:18432
  ds_read_b64_tr_b16 v[154:155], v212 offset:18688
  s_waitcnt lgkmcnt(12)
  v_mfma_f32_16x16x32_bf16 v[124:127], v[156:159], v[40:43], v[124:127]
  v_mfma_f32_16x16x32_bf16 v[128:131], v[160:163], v[40:43], v[128:131]
  s_add_u32 m0, s98, 12288
  s_add_u32 s52, s62, 344064
  buffer_load_dwordx4 v206, s[12:15], s52 offen lds
  ds_read_b64_tr_b16 v[156:157], v211 offset:20480
  ds_read_b64_tr_b16 v[158:159], v211 offset:20736
  ds_read_b64_tr_b16 v[160:161], v212 offset:20480
  ds_read_b64_tr_b16 v[162:163], v212 offset:20736
  s_waitcnt lgkmcnt(12)
  v_mfma_f32_16x16x32_bf16 v[124:127], v[164:167], v[44:47], v[124:127]
  v_mfma_f32_16x16x32_bf16 v[128:131], v[168:171], v[44:47], v[128:131]
  ds_read_b64_tr_b16 v[164:165], v211 offset:22528
  ds_read_b64_tr_b16 v[166:167], v211 offset:22784
  ds_read_b64_tr_b16 v[168:169], v212 offset:22528
  ds_read_b64_tr_b16 v[170:171], v212 offset:22784
  s_waitcnt lgkmcnt(12)
  v_mfma_f32_16x16x32_bf16 v[124:127], v[140:143], v[48:51], v[124:127]
  v_mfma_f32_16x16x32_bf16 v[128:131], v[144:147], v[48:51], v[128:131]
  ds_read_b64_tr_b16 v[140:141], v211 offset:24576
  ds_read_b64_tr_b16 v[142:143], v211 offset:24832
  ds_read_b64_tr_b16 v[144:145], v212 offset:24576
  ds_read_b64_tr_b16 v[146:147], v212 offset:24832
  s_waitcnt lgkmcnt(12)
  v_mfma_f32_16x16x32_bf16 v[124:127], v[148:151], v[52:55], v[124:127]
  v_mfma_f32_16x16x32_bf16 v[128:131], v[152:155], v[52:55], v[128:131]
  ds_read_b64_tr_b16 v[148:149], v211 offset:26624
  ds_read_b64_tr_b16 v[150:151], v211 offset:26880
  ds_read_b64_tr_b16 v[152:153], v212 offset:26624
  ds_read_b64_tr_b16 v[154:155], v212 offset:26880
  s_waitcnt lgkmcnt(12)
  v_mfma_f32_16x16x32_bf16 v[124:127], v[156:159], v[56:59], v[124:127]
  v_mfma_f32_16x16x32_bf16 v[128:131], v[160:163], v[56:59], v[128:131]
  s_add_u32 m0, s98, 13312
  s_add_u32 s52, s62, 688128
  buffer_load_dwordx4 v206, s[12:15], s52 offen lds
  s_waitcnt lgkmcnt(8)
  v_mfma_f32_16x16x32_bf16 v[124:127], v[164:167], v[60:63], v[124:127]
  v_mfma_f32_16x16x32_bf16 v[128:131], v[168:171], v[60:63], v[128:131]
  s_waitcnt lgkmcnt(4)
  v_mfma_f32_16x16x32_bf16 v[124:127], v[140:143], v[64:67], v[124:127]
  v_mfma_f32_16x16x32_bf16 v[128:131], v[144:147], v[64:67], v[128:131]
  s_waitcnt lgkmcnt(0)
  v_mfma_f32_16x16x32_bf16 v[124:127], v[148:151], v[68:71], v[124:127]
  v_mfma_f32_16x16x32_bf16 v[128:131], v[152:155], v[68:71], v[128:131]
  v_lshl_or_b32 v100, v108, 16, v100
  v_lshl_or_b32 v101, v109, 16, v101
  v_lshl_or_b32 v102, v110, 16, v102
  v_lshl_or_b32 v103, v111, 16, v103
  v_lshl_or_b32 v104, v112, 16, v104
  v_lshl_or_b32 v105, v113, 16, v105
  v_lshl_or_b32 v106, v114, 16, v106
  v_lshl_or_b32 v107, v115, 16, v107
  v_lshrrev_b32 v5, 1, v2
  v_mul_u32_u24 v5, 13312, v5
  v_add_u32 v211, v5, v207
  v_xor_b32 v212, 32, v211
  v_add_u32 v208, 57344, v211
  v_add_u32 v209, 57344, v212
  s_waitcnt vmcnt(13)
  s_barrier
  ds_read_b64_tr_b16 v[140:141], v211 offset:0
  ds_read_b64_tr_b16 v[142:143], v211 offset:256
  ds_read_b64_tr_b16 v[144:145], v212 offset:0
  ds_read_b64_tr_b16 v[146:147], v212 offset:256
  ds_read_b64_tr_b16 v[148:149], v211 offset:28672
  ds_read_b64_tr_b16 v[150:151], v211 offset:28928
  ds_read_b64_tr_b16 v[152:153], v212 offset:28672
  ds_read_b64_tr_b16 v[154:155], v212 offset:28928
  ds_read_b64_tr_b16 v[156:157], v208 offset:0
  ds_read_b64_tr_b16 v[158:159], v208 offset:256
  ds_read_b64_tr_b16 v[160:161], v209 offset:0
  ds_read_b64_tr_b16 v[162:163], v209 offset:256
  ds_read_b64_tr_b16 v[164:165], v208 offset:28672
  ds_read_b64_tr_b16 v[166:167], v208 offset:28928
  ds_read_b64_tr_b16 v[168:169], v209 offset:28672
  ds_read_b64_tr_b16 v[170:171], v209 offset:28928
  s_waitcnt lgkmcnt(12)
  v_mfma_f32_16x16x32_bf16 v[132:135], v[16:19], v[140:143], 0
  v_cvt_pk_bf16_f32 v172, v124, v125
  v_cvt_pk_bf16_f32 v173, v126, v127
  v_cvt_pk_bf16_f32 v174, v128, v129
  v_cvt_pk_bf16_f32 v175, v130, v131
  v_mfma_f32_16x16x32_bf16 v[136:139], v[16:19], v[144:147], 0
  s_nop 0
  v_mfma_f32_16x16x32_bf16 v[124:127], v[100:103], v[172:175], 0
  v_mfma_f32_16x16x32_bf16 v[128:131], v[104:107], v[172:175], 0
  s_nop 6
  v_max3_f32 v184, v124, v125, v126
  v_min3_f32 v185, v124, v125, v126
  ds_read_b64_tr_b16 v[140:141], v211 offset:1024
  ds_read_b64_tr_b16 v[142:143], v211 offset:1280
  ds_read_b64_tr_b16 v[144:145], v212 offset:1024
  ds_read_b64_tr_b16 v[146:147], v212 offset:1280
  s_waitcnt lgkmcnt(12)
  v_mfma_f32_16x16x32_bf16 v[132:135], v[20:23], v[148:151], v[132:135]
  v_max3_f32 v184, v184, v127, v128
  v_min3_f32 v185, v185, v127, v128
  v_max3_f32 v184, v184, v129, v130
  v_min3_f32 v185, v185, v129, v130
  v_mfma_f32_16x16x32_bf16 v[136:139], v[20:23], v[152:155], v[136:139]
  v_mov_b32 v186, v184
  v_mov_b32 v187, v185
  s_nop 0
  v_permlane16_swap_b32 v184, v186
  v_permlane16_swap_b32 v185, v187
  s_add_u32 m0, s98, 4096
  s_add_u32 s68, s70, 28672
  buffer_load_dwordx4 v213, s[20:23], s68 offen lds
  ds_read_b64_tr_b16 v[148:149], v211 offset:29696
  ds_read_b64_tr_b16 v[150:151], v211 offset:29952
  ds_read_b64_tr_b16 v[152:153], v212 offset:29696
  ds_read_b64_tr_b16 v[154:155], v212 offset:29952
  s_waitcnt lgkmcnt(12)
  v_mfma_f32_16x16x32_bf16 v[132:135], v[24:27], v[156:159], v[132:135]
  v_max_f32 v184, v184, v186
  v_min_f32 v185, v185, v187
  v_mov_b32 v186, v184
  v_mov_b32 v187, v185
  v_mfma_f32_16x16x32_bf16 v[136:139], v[24:27], v[160:163], v[136:139]
  v_permlane32_swap_b32 v184, v186
  v_permlane32_swap_b32 v185, v187
  v_max_f32 v184, v184, v186
  v_min_f32 v185, v185, v187
  ds_read_b64_tr_b16 v[156:157], v208 offset:1024
  ds_read_b64_tr_b16 v[158:159], v208 offset:1280
  ds_read_b64_tr_b16 v[160:161], v209 offset:1024
  ds_read_b64_tr_b16 v[162:163], v209 offset:1280
  s_waitcnt lgkmcnt(12)
  v_mfma_f32_16x16x32_bf16 v[132:135], v[28:31], v[164:167], v[132:135]
  v_mul_f32 v184, 0xbfb8aa3b, v184
  v_mul_f32 v185, 0x3fb8aa3b, v185
  v_fma_f32 v176, v124, s92, v184
  v_fma_f32 v188, -v124, s92, v185
  v_mfma_f32_16x16x32_bf16 v[136:139], v[28:31], v[168:171], v[136:139]
  v_fma_f32 v177, v125, s92, v184
  v_fma_f32 v189, -v125, s92, v185
  v_fma_f32 v178, v126, s92, v184
  v_fma_f32 v190, -v126, s92, v185
  s_add_u32 m0, s98, 5120
  s_add_u32 s68, s70, 35840
  buffer_load_dwordx4 v213, s[20:23], s68 offen lds
  ds_read_b64_tr_b16 v[164:165], v208 offset:29696
  ds_read_b64_tr_b16 v[166:167], v208 offset:29952
  ds_read_b64_tr_b16 v[168:169], v209 offset:29696
  ds_read_b64_tr_b16 v[170:171], v209 offset:29952
  s_waitcnt lgkmcnt(12)
  v_mfma_f32_16x16x32_bf16 v[132:135], v[32:35], v[140:143], v[132:135]
  v_fma_f32 v179, v127, s92, v184
  v_fma_f32 v191, -v127, s92, v185
  v_fma_f32 v180, v128, s92, v184
  v_fma_f32 v192, -v128, s92, v185
  v_mfma_f32_16x16x32_bf16 v[136:139], v[32:35], v[144:147], v[136:139]
  v_fma_f32 v181, v129, s92, v184
  v_fma_f32 v193, -v129, s92, v185
  v_fma_f32 v182, v130, s92, v184
  v_fma_f32 v194, -v130, s92, v185
  ds_read_b64_tr_b16 v[140:141], v211 offset:2048
  ds_read_b64_tr_b16 v[142:143], v211 offset:2304
  ds_read_b64_tr_b16 v[144:145], v212 offset:2048
  ds_read_b64_tr_b16 v[146:147], v212 offset:2304
  s_waitcnt lgkmcnt(12)
  v_mfma_f32_16x16x32_bf16 v[132:135], v[36:39], v[148:151], v[132:135]
  v_exp_f32 v176, v176
  v_exp_f32 v188, v188
  v_exp_f32 v177, v177
  v_exp_f32 v189, v189
  v_mfma_f32_16x16x32_bf16 v[136:139], v[36:39], v[152:155], v[136:139]
  v_exp_f32 v178, v178
  v_exp_f32 v190, v190
  v_exp_f32 v179, v179
  v_exp_f32 v191, v191
  s_add_u32 m0, s98, 6144
  s_add_u32 s68, s70, 43008
  buffer_load_dwordx4 v213, s[20:23], s68 offen lds
  ds_read_b64_tr_b16 v[148:149], v211 offset:30720
  ds_read_b64_tr_b16 v[150:151], v211 offset:30976
  ds_read_b64_tr_b16 v[152:153], v212 offset:30720
  ds_read_b64_tr_b16 v[154:155], v212 offset:30976
  s_waitcnt lgkmcnt(12)
  v_mfma_f32_16x16x32_bf16 v[132:135], v[40:43], v[156:159], v[132:135]
  v_exp_f32 v180, v180
  v_exp_f32 v192, v192
  v_exp_f32 v181, v181
  v_exp_f32 v193, v193
  v_mfma_f32_16x16x32_bf16 v[136:139], v[40:43], v[160:163], v[136:139]
  v_exp_f32 v182, v182
  v_exp_f32 v194, v194
  v_add_f32 v184, v176, v177
  v_add_f32 v185, v188, v189
  ds_read_b64_tr_b16 v[156:157], v208 offset:2048
  ds_read_b64_tr_b16 v[158:159], v208 offset:2304
  ds_read_b64_tr_b16 v[160:161], v209 offset:2048
  ds_read_b64_tr_b16 v[162:163], v209 offset:2304
  s_waitcnt lgkmcnt(12)
  v_mfma_f32_16x16x32_bf16 v[132:135], v[44:47], v[164:167], v[132:135]
  v_add_f32 v184, v184, v178
  v_add_f32 v185, v185, v190
  v_add_f32 v184, v184, v179
  v_add_f32 v185, v185, v191
  v_mfma_f32_16x16x32_bf16 v[136:139], v[44:47], v[168:171], v[136:139]
  v_add_f32 v184, v184, v180
  v_add_f32 v185, v185, v192
  v_add_f32 v184, v184, v181
  v_add_f32 v185, v185, v193
  s_add_u32 m0, s98, 7168
  s_add_u32 s68, s70, 50176
  buffer_load_dwordx4 v213, s[20:23], s68 offen lds
  ds_read_b64_tr_b16 v[164:165], v208 offset:30720
  ds_read_b64_tr_b16 v[166:167], v208 offset:30976
  ds_read_b64_tr_b16 v[168:169], v209 offset:30720
  ds_read_b64_tr_b16 v[170:171], v209 offset:30976
  s_waitcnt lgkmcnt(12)
  v_mfma_f32_16x16x32_bf16 v[132:135], v[48:51], v[140:143], v[132:135]
  v_add_f32 v184, v184, v182
  v_add_f32 v185, v185, v194
  v_mov_b32 v186, v184
  v_mov_b32 v187, v185
  v_mfma_f32_16x16x32_bf16 v[136:139], v[48:51], v[144:147], v[136:139]
  v_permlane16_swap_b32 v184, v186
  v_permlane16_swap_b32 v185, v187
  v_add_f32 v184, v184, v186
  v_add_f32 v185, v185, v187
  ds_read_b64_tr_b16 v[140:141], v211 offset:3072
  ds_read_b64_tr_b16 v[142:143], v211 offset:3328
  ds_read_b64_tr_b16 v[144:145], v212 offset:3072
  ds_read_b64_tr_b16 v[146:147], v212 offset:3328
  s_waitcnt lgkmcnt(12)
  v_mfma_f32_16x16x32_bf16 v[132:135], v[52:55], v[148:151], v[132:135]
  v_mov_b32 v186, v184
  v_mov_b32 v187, v185
  s_nop 0
  v_permlane32_swap_b32 v184, v186
  v_permlane32_swap_b32 v185, v187
  v_mfma_f32_16x16x32_bf16 v[136:139], v[52:55], v[152:155], v[136:139]
  v_add_f32 v184, v184, v186
  v_add_f32 v185, v185, v187
  v_rcp_f32 v184, v184
  v_rcp_f32 v185, v185
  s_add_u32 m0, s98, 8192
  s_add_u32 s68, s70, 57344
  buffer_load_dwordx4 v213, s[20:23], s68 offen lds
  ds_read_b64_tr_b16 v[148:149], v211 offset:31744
  ds_read_b64_tr_b16 v[150:151], v211 offset:32000
  ds_read_b64_tr_b16 v[152:153], v212 offset:31744
  ds_read_b64_tr_b16 v[154:155], v212 offset:32000
  s_waitcnt lgkmcnt(12)
  v_mfma_f32_16x16x32_bf16 v[132:135], v[56:59], v[156:159], v[132:135]
  v_mul_f32 v176, v176, v184
  v_mul_f32 v188, v188, v185
  v_mul_f32 v177, v177, v184
  v_mul_f32 v189, v189, v185
  v_mfma_f32_16x16x32_bf16 v[136:139], v[56:59], v[160:163], v[136:139]
  v_mul_f32 v178, v178, v184
  v_mul_f32 v190, v190, v185
  v_mul_f32 v179, v179, v184
  v_mul_f32 v191, v191, v185
  s_waitcnt lgkmcnt(8)
  v_mfma_f32_16x16x32_bf16 v[132:135], v[60:63], v[164:167], v[132:135]
  v_mul_f32 v180, v180, v184
  v_mul_f32 v192, v192, v185
  v_mul_f32 v181, v181, v184
  v_mul_f32 v193, v193, v185
  v_mfma_f32_16x16x32_bf16 v[136:139], v[60:63], v[168:171], v[136:139]
  v_mul_f32 v182, v182, v184
  v_mul_f32 v194, v194, v185
  v_cvt_pk_bf16_f32 v196, v176, v177
  v_cvt_pk_bf16_f32 v200, v188, v189
  s_add_u32 m0, s98, 9216
  s_add_u32 s68, s70, 64512
  buffer_load_dwordx4 v213, s[20:23], s68 offen lds
  s_waitcnt lgkmcnt(4)
  v_mfma_f32_16x16x32_bf16 v[132:135], v[64:67], v[140:143], v[132:135]
  v_cvt_pk_bf16_f32 v197, v178, v179
  v_cvt_pk_bf16_f32 v201, v190, v191
  v_cvt_pk_bf16_f32 v198, v180, v181
  v_cvt_pk_bf16_f32 v202, v192, v193
  v_mfma_f32_16x16x32_bf16 v[136:139], v[64:67], v[144:147], v[136:139]
  v_cvt_pk_bf16_f32 v199, v182, 0
  v_cvt_pk_bf16_f32 v203, v194, 0
  s_nop 0
  v_mfma_f32_16x16x32_bf16 v[172:175], v[196:199], v[116:119], 0
  v_mfma_f32_16x16x32_bf16 v[176:179], v[196:199], v[120:123], 0
  s_waitcnt lgkmcnt(0)
  v_mfma_f32_16x16x32_bf16 v[132:135], v[68:71], v[148:151], v[132:135]
  v_mfma_f32_16x16x32_bf16 v[180:183], v[200:203], v[116:119], 0
  v_mfma_f32_16x16x32_bf16 v[184:187], v[200:203], v[120:123], 0
  v_mfma_f32_16x16x32_bf16 v[136:139], v[68:71], v[152:155], v[136:139]
  s_nop 1
  v_cvt_pk_bf16_f32 v196, v172, v173
  v_cvt_pk_bf16_f32 v197, v174, v175
  v_cvt_pk_bf16_f32 v198, v176, v177
  v_cvt_pk_bf16_f32 v199, v178, v179
  v_cvt_pk_bf16_f32 v200, v180, v181
  v_cvt_pk_bf16_f32 v201, v182, v183
  v_cvt_pk_bf16_f32 v202, v184, v185
  v_cvt_pk_bf16_f32 v203, v186, v187
  v_cmp_le_u32 vcc, 12, v3
  v_cvt_pk_bf16_f32 v124, v132, v133
  v_cvt_pk_bf16_f32 v125, v134, v135
  v_cvt_pk_bf16_f32 v126, v136, v137
  v_cvt_pk_bf16_f32 v127, v138, v139
  v_cndmask_b32 v126, v126, v10, vcc
  v_cndmask_b32 v127, v127, v10, vcc
  s_lshr_b32 s51, s50, 1
  s_lshl_b32 s51, s51, 10
  s_and_b32 s52, s50, 1
  s_lshl_b32 s52, s52, 3
  s_add_u32 s51, s51, s52
  s_add_u32 s51, s51, 114688
  v_add_u32 v5, s51, v4
  ds_write_b64 v5, v[196:197] offset:0
  ds_write_b64 v5, v[198:199] offset:4096
  ds_write_b64 v5, v[200:201] offset:8192
  ds_write_b64 v5, v[202:203] offset:12288
  ds_write_b64 v5, v[124:125] offset:16384
  ds_write_b64 v5, v[126:127] offset:20480
  s_waitcnt vmcnt(9)
  v_mov_b32 v132, 0
  v_mov_b32 v133, 0
  v_dot2_f32_bf16 v132, v248, v8, v132
  v_dot2_f32_bf16 v133, v248, v9, v133
  v_dot2_f32_bf16 v132, v249, v8, v132
  v_dot2_f32_bf16 v133, v249, v9, v133
  v_dot2_f32_bf16 v132, v250, v8, v132
  v_dot2_f32_bf16 v133, v250, v9, v133
  v_dot2_f32_bf16 v132, v251, v8, v132
  v_dot2_f32_bf16 v133, v251, v9, v133
  v_dot2_f32_bf16 v132, v252, v8, v132
  v_dot2_f32_bf16 v133, v252, v9, v133
  v_dot2_f32_bf16 v132, v253, v8, v132
  v_dot2_f32_bf16 v133, v253, v9, v133
  v_dot2_f32_bf16 v132, v254, v8, v132
  v_dot2_f32_bf16 v133, v254, v9, v133
  v_lshlrev_b32 v6, 3, v0
  v_add_u32 v6, 157696, v6
  s_nop 0
  ds_write_b64 v6, v[132:133]
  s_lshl_b32 s51, s58, 1
  s_and_b32 s52, s50, 1
  s_add_u32 s51, s51, s52
  s_lshl_b32 s51, s51, 12
  s_add_u32 s51, s51, 114688
  v_add_u32 v5, s51, v4
  s_bfe_u32 s51, s50, 0x10001
  s_lshl_b32 s51, s51, 12
  s_add_u32 s51, s51, 131072
  v_add_u32 v6, s51, v4
  s_waitcnt vmcnt(6)
  s_waitcnt lgkmcnt(0)
  s_barrier
  ds_read_b128 v[140:143], v5 offset:0
  ds_read_b128 v[144:147], v6 offset:0
  ds_read_b128 v[148:151], v5 offset:1024
  ds_read_b128 v[152:155], v6 offset:1024
  ds_read_b128 v[156:159], v5 offset:2048
  ds_read_b128 v[160:163], v6 offset:2048
  ds_read_b128 v[164:167], v5 offset:3072
  ds_read_b128 v[168:171], v6 offset:3072
  v_lshlrev_b32 v204, 2, v0
  v_and_b32 v204, 1023, v204
  v_add_u32 v204, 157696, v204
  ds_read2st64_b32 v[132:133], v204 offset0:0 offset1:4
  ds_read2st64_b32 v[134:135], v204 offset0:8 offset1:12
  s_waitcnt lgkmcnt(8)
  v_mfma_f32_16x16x32_bf16 v[124:127], v[140:143], v[144:147], 0
  s_waitcnt lgkmcnt(6)
  v_mfma_f32_16x16x32_bf16 v[124:127], v[148:151], v[152:155], v[124:127]
  s_waitcnt lgkmcnt(4)
  v_mfma_f32_16x16x32_bf16 v[124:127], v[156:159], v[160:163], v[124:127]
  s_waitcnt lgkmcnt(2)
  v_mfma_f32_16x16x32_bf16 v[124:127], v[164:167], v[168:171], v[124:127]
  s_waitcnt lgkmcnt(0)
  v_add_f32 v132, v132, v133
  v_add_f32 v134, v134, v135
  v_add_f32 v132, v132, v134
  s_nop 3
  v_cvt_pk_bf16_f32 v128, v124, v125
  v_cvt_pk_bf16_f32 v129, v126, v127
  buffer_store_dwordx2 v[128:129], v210, s[44:47], s71 offen sc1
  buffer_store_dword v132, v214, s[44:47], s78 offen sc1
  s_mov_b64 s[4:5], s[24:25]
  s_cmp_eq_u32 s50, 1
  s_cselect_b32 s4, s28, s4
  s_cselect_b32 s5, s29, s5
  s_cmp_eq_u32 s50, 2
  s_cselect_b32 s4, s32, s4
  s_cselect_b32 s5, s33, s5
  s_cmp_eq_u32 s50, 3
  s_cselect_b32 s4, s20, s4
  s_cselect_b32 s5, s21, s5
  s_mov_b32 s6, 1605632
  s_cmov_b32 s6, 401408
  s_mov_b32 s7, 0x20000
  s_mov_b32 s51, 49
  s_cmov_b32 s51, 13
  s_mul_i32 s52, s2, s51
  s_lshl_b32 s52, s52, 7
  s_sub_u32 s51, s51, 1
  s_cmp_ge_u32 s50, 4
  s_cselect_b32 s53, 2146435072, 0
  s_add_u32 s52, s52, s53
  v_min_u32 v99, s51, v1
  v_lshlrev_b32 v99, 7, v99
  buffer_load_dword v98, v99, s[4:7], s52 offen
  v_lshlrev_b32 v13, 4, v3
  buffer_load_dword v14, v13, s[40:43], s91 offen sc1
  ds_read_b64_tr_b16 v[140:141], v211 offset:11264
  ds_read_b64_tr_b16 v[142:143], v211 offset:11520
  ds_read_b64_tr_b16 v[144:145], v212 offset:11264
  ds_read_b64_tr_b16 v[146:147], v212 offset:11520
  ds_read_b64_tr_b16 v[148:149], v211 offset:39936
  ds_read_b64_tr_b16 v[150:151], v211 offset:40192
  ds_read_b64_tr_b16 v[152:153], v212 offset:39936
  ds_read_b64_tr_b16 v[154:155], v212 offset:40192
  ds_read_b64_tr_b16 v[156:157], v208 offset:11264
  ds_read_b64_tr_b16 v[158:159], v208 offset:11520
  ds_read_b64_tr_b16 v[160:161], v209 offset:11264
  ds_read_b64_tr_b16 v[162:163], v209 offset:11520
  ds_read_b64_tr_b16 v[164:165], v208 offset:39936
  ds_read_b64_tr_b16 v[166:167], v208 offset:40192
  ds_read_b64_tr_b16 v[168:169], v209 offset:39936
  ds_read_b64_tr_b16 v[170:171], v209 offset:40192
  s_waitcnt lgkmcnt(12)
  v_mfma_f32_16x16x32_bf16 v[124:127], v[140:143], v[16:19], 0
  v_mfma_f32_16x16x32_bf16 v[128:131], v[144:147], v[16:19], 0
  ds_read_b64_tr_b16 v[140:141], v211 offset:12288
  ds_read_b64_tr_b16 v[142:143], v211 offset:12544
  ds_read_b64_tr_b16 v[144:145], v212 offset:12288
  ds_read_b64_tr_b16 v[146:147], v212 offset:12544
  s_waitcnt lgkmcnt(12)
  v_mfma_f32_16x16x32_bf16 v[124:127], v[148:151], v[20:23], v[124:127]
  v_mfma_f32_16x16x32_bf16 v[128:131], v[152:155], v[20:23], v[128:131]
  s_add_u32 m0, s98, 0
  s_add_u32 s68, s70, 0
  buffer_load_dwordx4 v213, s[20:23], s68 offen lds
  ds_read_b64_tr_b16 v[148:149], v211 offset:40960
  ds_read_b64_tr_b16 v[150:151], v211 offset:41216
  ds_read_b64_tr_b16 v[152:153], v212 offset:40960
  ds_read_b64_tr_b16 v[154:155], v212 offset:41216
  s_waitcnt lgkmcnt(12)
  v_mfma_f32_16x16x32_bf16 v[124:127], v[156:159], v[24:27], v[124:127]
  v_mfma_f32_16x16x32_bf16 v[128:131], v[160:163], v[24:27], v[128:131]
  ds_read_b64_tr_b16 v[156:157], v208 offset:12288
  ds_read_b64_tr_b16 v[158:159], v208 offset:12544
  ds_read_b64_tr_b16 v[160:161], v209 offset:12288
  ds_read_b64_tr_b16 v[162:163], v209 offset:12544
  s_waitcnt lgkmcnt(12)
  v_mfma_f32_16x16x32_bf16 v[124:127], v[164:167], v[28:31], v[124:127]
  v_mfma_f32_16x16x32_bf16 v[128:131], v[168:171], v[28:31], v[128:131]
  s_add_u32 m0, s98, 1024
  s_add_u32 s68, s70, 7168
  buffer_load_dwordx4 v213, s[20:23], s68 offen lds
  ds_read_b64_tr_b16 v[164:165], v208 offset:40960
  ds_read_b64_tr_b16 v[166:167], v208 offset:41216
  ds_read_b64_tr_b16 v[168:169], v209 offset:40960
  ds_read_b64_tr_b16 v[170:171], v209 offset:41216
  s_waitcnt lgkmcnt(12)
  v_mfma_f32_16x16x32_bf16 v[124:127], v[140:143], v[32:35], v[124:127]
  v_mfma_f32_16x16x32_bf16 v[128:131], v[144:147], v[32:35], v[128:131]
  ds_read_b64_tr_b16 v[140:141], v211 offset:13312
  ds_read_b64_tr_b16 v[142:143], v211 offset:13568
  ds_read_b64_tr_b16 v[144:145], v212 offset:13312
  ds_read_b64_tr_b16 v[146:147], v212 offset:13568
  s_waitcnt lgkmcnt(12)
  v_mfma_f32_16x16x32_bf16 v[124:127], v[148:151], v[36:39], v[124:127]
  v_mfma_f32_16x16x32_bf16 v[128:131], v[152:155], v[36:39], v[128:131]
  s_add_u32 m0, s98, 2048
  s_add_u32 s68, s70, 14336
  buffer_load_dwordx4 v213, s[20:23], s68 offen lds
  ds_read_b64_tr_b16 v[148:149], v211 offset:41984
  ds_read_b64_tr_b16 v[150:151], v211 offset:42240
  ds_read_b64_tr_b16 v[152:153], v212 offset:41984
  ds_read_b64_tr_b16 v[154:155], v212 offset:42240
  s_waitcnt lgkmcnt(12)
  v_mfma_f32_16x16x32_bf16 v[124:127], v[156:159], v[40:43], v[124:127]
  v_mfma_f32_16x16x32_bf16 v[128:131], v[160:163], v[40:43], v[128:131]
  ds_read_b64_tr_b16 v[156:157], v208 offset:13312
  ds_read_b64_tr_b16 v[158:159], v208 offset:13568
  ds_read_b64_tr_b16 v[160:161], v209 offset:13312
  ds_read_b64_tr_b16 v[162:163], v209 offset:13568
  s_waitcnt lgkmcnt(12)
  v_mfma_f32_16x16x32_bf16 v[124:127], v[164:167], v[44:47], v[124:127]
  v_mfma_f32_16x16x32_bf16 v[128:131], v[168:171], v[44:47], v[128:131]
  s_add_u32 m0, s98, 3072
  s_add_u32 s68, s70, 21504
  buffer_load_dwordx4 v213, s[20:23], s68 offen lds
  ds_read_b64_tr_b16 v[164:165], v208 offset:41984
  ds_read_b64_tr_b16 v[166:167], v208 offset:42240
  ds_read_b64_tr_b16 v[168:169], v209 offset:41984
  ds_read_b64_tr_b16 v[170:171], v209 offset:42240
  s_waitcnt lgkmcnt(12)
  v_mfma_f32_16x16x32_bf16 v[124:127], v[140:143], v[48:51], v[124:127]
  v_mfma_f32_16x16x32_bf16 v[128:131], v[144:147], v[48:51], v[128:131]
  ds_read_b64_tr_b16 v[140:141], v208 offset:10240
  ds_read_b64_tr_b16 v[142:143], v208 offset:10496
  ds_read_b64_tr_b16 v[144:145], v209 offset:10240
  ds_read_b64_tr_b16 v[146:147], v209 offset:10496
  s_waitcnt lgkmcnt(12)
  v_mfma_f32_16x16x32_bf16 v[124:127], v[148:151], v[52:55], v[124:127]
  v_mfma_f32_16x16x32_bf16 v[128:131], v[152:155], v[52:55], v[128:131]
  ds_read_b64_tr_b16 v[148:149], v208 offset:38912
  ds_read_b64_tr_b16 v[150:151], v208 offset:39168
  ds_read_b64_tr_b16 v[152:153], v209 offset:38912
  ds_read_b64_tr_b16 v[154:155], v209 offset:39168
  s_waitcnt lgkmcnt(12)
  v_mfma_f32_16x16x32_bf16 v[124:127], v[156:159], v[56:59], v[124:127]
  v_mfma_f32_16x16x32_bf16 v[128:131], v[160:163], v[56:59], v[128:131]
  s_waitcnt lgkmcnt(8)
  v_mfma_f32_16x16x32_bf16 v[124:127], v[164:167], v[60:63], v[124:127]
  v_mfma_f32_16x16x32_bf16 v[128:131], v[168:171], v[60:63], v[128:131]
  s_waitcnt lgkmcnt(4)
  v_mfma_f32_16x16x32_bf16 v[124:127], v[140:143], v[64:67], v[124:127]
  v_mfma_f32_16x16x32_bf16 v[128:131], v[144:147], v[64:67], v[128:131]
  s_waitcnt lgkmcnt(0)
  v_mfma_f32_16x16x32_bf16 v[124:127], v[148:151], v[68:71], v[124:127]
  v_mfma_f32_16x16x32_bf16 v[128:131], v[152:155], v[68:71], v[128:131]
  s_cmp_lg_u32 s50, 0
  s_cbranch_scc1 L_ib_4
  s_waitcnt vmcnt(4)
  v_cmp_gt_u32 vcc, 16, v14
  s_nop 1
  s_cmp_lg_u64 vcc, 0
  s_cbranch_scc1 L_ir_3
L_ib_4:
  s_barrier
  s_add_u32 m0, s98, 10240
  s_add_u32 s68, s70, 71680
  buffer_load_dwordx4 v213, s[20:23], s68 offen lds
  s_add_u32 m0, s98, 11264
  s_add_u32 s68, s70, 78848
  buffer_load_dwordx4 v213, s[20:23], s68 offen lds
  s_add_u32 m0, s98, 12288
  s_add_u32 s68, s70, 86016
  buffer_load_dwordx4 v213, s[20:23], s68 offen lds
  s_add_u32 m0, s98, 13312
  s_add_u32 s68, s70, 93184
  buffer_load_dwordx4 v213, s[20:23], s68 offen lds
  v_cvt_pk_bf16_f32 v172, v124, v125
  v_cvt_pk_bf16_f32 v173, v126, v127
  v_cvt_pk_bf16_f32 v174, v128, v129
  v_cvt_pk_bf16_f32 v175, v130, v131
  s_nop 1
  v_mfma_f32_16x16x32_bf16 v[124:127], v[100:103], v[172:175], 0
  v_mfma_f32_16x16x32_bf16 v[128:131], v[104:107], v[172:175], 0
  s_nop 6
  v_max3_f32 v184, v124, v125, v126
  v_min3_f32 v185, v124, v125, v126
  v_max3_f32 v184, v184, v127, v128
  v_min3_f32 v185, v185, v127, v128
  v_max3_f32 v184, v184, v129, v130
  v_min3_f32 v185, v185, v129, v130
  v_mov_b32 v186, v184
  v_mov_b32 v187, v185
  s_nop 0
  v_permlane16_swap_b32 v184, v186
  v_permlane16_swap_b32 v185, v187
  v_max_f32 v184, v184, v186
  v_min_f32 v185, v185, v187
  v_mov_b32 v186, v184
  v_mov_b32 v187, v185
  s_nop 0
  v_permlane32_swap_b32 v184, v186
  v_permlane32_swap_b32 v185, v187
  v_max_f32 v184, v184, v186
  v_min_f32 v185, v185, v187
  v_mul_f32 v184, 0xbfb8aa3b, v184
  v_mul_f32 v185, 0x3fb8aa3b, v185
  v_fma_f32 v176, v124, s92, v184
  v_fma_f32 v188, -v124, s92, v185
  v_fma_f32 v177, v125, s92, v184
  v_fma_f32 v189, -v125, s92, v185
  v_fma_f32 v178, v126, s92, v184
  v_fma_f32 v190, -v126, s92, v185
  v_fma_f32 v179, v127, s92, v184
  v_fma_f32 v191, -v127, s92, v185
  v_fma_f32 v180, v128, s92, v184
  v_fma_f32 v192, -v128, s92, v185
  v_fma_f32 v181, v129, s92, v184
  v_fma_f32 v193, -v129, s92, v185
  v_fma_f32 v182, v130, s92, v184
  v_fma_f32 v194, -v130, s92, v185
  v_exp_f32 v176, v176
  v_exp_f32 v188, v188
  v_exp_f32 v177, v177
  v_exp_f32 v189, v189
  v_exp_f32 v178, v178
  v_exp_f32 v190, v190
  v_exp_f32 v179, v179
  v_exp_f32 v191, v191
  v_exp_f32 v180, v180
  v_exp_f32 v192, v192
  v_exp_f32 v181, v181
  v_exp_f32 v193, v193
  v_exp_f32 v182, v182
  v_exp_f32 v194, v194
  v_add_f32 v184, v176, v177
  v_add_f32 v185, v188, v189
  v_add_f32 v184, v184, v178
  v_add_f32 v185, v185, v190
  v_add_f32 v184, v184, v179
  v_add_f32 v185, v185, v191
  v_add_f32 v184, v184, v180
  v_add_f32 v185, v185, v192
  v_add_f32 v184, v184, v181
  v_add_f32 v185, v185, v193
  v_add_f32 v184, v184, v182
  v_add_f32 v185, v185, v194
  v_mov_b32 v186, v184
  v_mov_b32 v187, v185
  s_nop 0
  v_permlane16_swap_b32 v184, v186
  v_permlane16_swap_b32 v185, v187
  v_add_f32 v184, v184, v186
  v_add_f32 v185, v185, v187
  v_mov_b32 v186, v184
  v_mov_b32 v187, v185
  s_nop 0
  v_permlane32_swap_b32 v184, v186
  v_permlane32_swap_b32 v185, v187
  v_add_f32 v184, v184, v186
  v_add_f32 v185, v185, v187
  v_rcp_f32 v184, v184
  v_rcp_f32 v185, v185
  v_mul_f32 v176, v176, v184
  v_mul_f32 v188, v188, v185
  v_mul_f32 v177, v177, v184
  v_mul_f32 v189, v189, v185
  v_mul_f32 v178, v178, v184
  v_mul_f32 v190, v190, v185
  v_mul_f32 v179, v179, v184
  v_mul_f32 v191, v191, v185
  v_mul_f32 v180, v180, v184
  v_mul_f32 v192, v192, v185
  v_mul_f32 v181, v181, v184
  v_mul_f32 v193, v193, v185
  v_mul_f32 v182, v182, v184
  v_mul_f32 v194, v194, v185
  v_cvt_pk_bf16_f32 v196, v176, v177
  v_cvt_pk_bf16_f32 v200, v188, v189
  v_cvt_pk_bf16_f32 v197, v178, v179
  v_cvt_pk_bf16_f32 v201, v190, v191
  v_cvt_pk_bf16_f32 v198, v180, v181
  v_cvt_pk_bf16_f32 v202, v192, v193
  v_cvt_pk_bf16_f32 v199, v182, 0
  v_cvt_pk_bf16_f32 v203, v194, 0
  s_lshl_b32 s51, s58, 15
  s_lshl_b32 s52, s57, 10
  s_add_u32 s88, s88, s51
  s_add_u32 s88, s88, s52
  s_mov_b32 s51, s88
  buffer_load_dwordx4 v[40:43], v4, s[44:47], s51 offen sc1
  s_add_u32 s51, s51, 4096
  buffer_load_dwordx4 v[44:47], v4, s[44:47], s51 offen sc1
  s_add_u32 s51, s51, 4096
  buffer_load_dwordx4 v[48:51], v4, s[44:47], s51 offen sc1
  s_add_u32 s51, s51, 4096
  buffer_load_dwordx4 v[52:55], v4, s[44:47], s51 offen sc1
  s_add_u32 s51, s51, 4096
  buffer_load_dwordx4 v[56:59], v4, s[44:47], s51 offen sc1
  s_add_u32 s51, s51, 4096
  buffer_load_dwordx4 v[60:63], v4, s[44:47], s51 offen sc1
  s_add_u32 s51, s51, 4096
  buffer_load_dwordx4 v[64:67], v4, s[44:47], s51 offen sc1
  s_add_u32 s51, s51, 4096
  buffer_load_dwordx4 v[68:71], v4, s[44:47], s51 offen sc1
  v_lshrrev_b32 v5, 3, v1
  v_mul_u32_u24 v6, 3584, v5
  v_and_b32 v7, 1, v2
  v_lshlrev_b32 v7, 2, v7
  v_and_b32 v252, 7, v1
  v_xor_b32 v252, v252, v7
  v_lshl_add_u32 v252, v252, 4, v6
  s_cmp_ge_u32 s95, 14
  s_cselect_b32 s51, 2146435072, 0
  v_add_u32 v252, s51, v252
  s_mul_i32 s90, s50, 28672
  s_lshl_b32 s51, s95, 8
  s_add_u32 s90, s90, s51
  v_lshrrev_b32 v254, 5, v1
  v_and_b32 v255, 31, v1
  v_lshrrev_b32 v5, 3, v1
  v_mul_u32_u24 v5, 896, v5
  v_and_b32 v6, 1, v2
  v_lshlrev_b32 v6, 2, v6
  v_and_b32 v253, 7, v1
  v_xor_b32 v253, v253, v6
  v_lshl_add_u32 v253, v253, 4, v5
  s_cmp_ge_u32 s94, 7
  s_cselect_b32 s64, 1, 0
  s_mul_i32 s51, s64, 7
  s_sub_u32 s65, s94, s51
  s_lshl_b32 s51, s58, 1
  s_add_u32 s51, s51, s50
  s_and_b32 s66, s51, 3
  s_mul_i32 s67, s58, 56
  s_add_u32 s67, s67, s66
  s_mul_i32 s80, s67, 14336
  s_lshl_b32 s52, s65, 7
  s_add_u32 s80, s80, s52
  s_cmp_ge_u32 s94, 14
  s_cselect_b32 s52, 2146435072, 0
  s_add_u32 s80, s80, s52
  v_lshrrev_b32 v191, 2, v3
  v_sub_u32 v191, v3, v191
  v_and_b32 v6, 3, v3
  v_cmp_eq_u32 vcc, 3, v6
  s_nop 1
  v_cndmask_b32 v191, v191, 12, vcc
  v_lshl_add_u32 v191, v2, 4, v191
  v_lshlrev_b32 v191, 4, v191
  v_add_u32 v191, 143360, v191
  v_add_u32 v192, 143360, v4
  v_and_b32 v193, 31, v1
  v_lshlrev_b32 v193, 5, v193
  v_lshrrev_b32 v6, 5, v1
  v_lshl_add_u32 v193, v6, 3, v193
  v_add_u32 v193, s91, v193
  v_add_u32 v193, 143360, v193
  v_bfe_u32 v6, v1, 2, 2
  v_lshl_add_u32 v188, v2, 2, v6
  v_min_u32 v6, 2, v6
  v_mad_u32_u24 v189, v2, 3, v6
  v_add_u32 v189, 16, v189
  v_and_b32 v6, 3, v1
  v_lshlrev_b32 v6, 3, v6
  v_add_u32 v6, s98, v6
  v_bfe_u32 v7, v188, 1, 2
  v_lshlrev_b32 v7, 5, v7
  v_lshl_add_u32 v7, v188, 7, v7
  v_add_u32 v72, v7, v6
  v_xor_b32 v73, 32, v72
  v_xor_b32 v74, 64, v72
  v_xor_b32 v75, 96, v72
  v_bfe_u32 v7, v189, 1, 2
  v_lshlrev_b32 v7, 5, v7
  v_lshl_add_u32 v7, v189, 7, v7
  v_add_u32 v76, v7, v6
  v_xor_b32 v77, 32, v76
  v_xor_b32 v78, 64, v76
  v_xor_b32 v79, 96, v76
  s_waitcnt vmcnt(8)
  ds_read_b64_tr_b16 v[112:113], v72 offset:0
  ds_read_b64_tr_b16 v[114:115], v76 offset:0
  ds_read_b64_tr_b16 v[116:117], v73 offset:0
  ds_read_b64_tr_b16 v[118:119], v77 offset:0
  ds_read_b64_tr_b16 v[120:121], v74 offset:0
  ds_read_b64_tr_b16 v[122:123], v78 offset:0
  ds_read_b64_tr_b16 v[124:125], v75 offset:0
  ds_read_b64_tr_b16 v[126:127], v79 offset:0
  ds_read_b64_tr_b16 v[128:129], v74 offset:3584
  ds_read_b64_tr_b16 v[130:131], v78 offset:3584
  ds_read_b64_tr_b16 v[132:133], v75 offset:3584
  ds_read_b64_tr_b16 v[134:135], v79 offset:3584
  ds_read_b64_tr_b16 v[136:137], v72 offset:3584
  ds_read_b64_tr_b16 v[138:139], v76 offset:3584
  ds_read_b64_tr_b16 v[140:141], v73 offset:3584
  ds_read_b64_tr_b16 v[142:143], v77 offset:3584
  ds_read_b64_tr_b16 v[144:145], v72 offset:7168
  ds_read_b64_tr_b16 v[146:147], v76 offset:7168
  ds_read_b64_tr_b16 v[148:149], v73 offset:7168
  ds_read_b64_tr_b16 v[150:151], v77 offset:7168
  ds_read_b64_tr_b16 v[152:153], v74 offset:7168
  ds_read_b64_tr_b16 v[154:155], v78 offset:7168
  ds_read_b64_tr_b16 v[156:157], v75 offset:7168
  ds_read_b64_tr_b16 v[158:159], v79 offset:7168
  ds_read_b64_tr_b16 v[160:161], v74 offset:10752
  ds_read_b64_tr_b16 v[162:163], v78 offset:10752
  ds_read_b64_tr_b16 v[164:165], v75 offset:10752
  ds_read_b64_tr_b16 v[166:167], v79 offset:10752
  ds_read_b64_tr_b16 v[168:169], v72 offset:10752
  ds_read_b64_tr_b16 v[170:171], v76 offset:10752
  ds_read_b64_tr_b16 v[172:173], v73 offset:10752
  ds_read_b64_tr_b16 v[174:175], v77 offset:10752
  v_mov_b32 v96, 0
  v_mov_b32 v97, 0
  v_mov_b32 v98, 0
  v_mov_b32 v99, 0
  v_mov_b32 v100, 0
  v_mov_b32 v101, 0
  v_mov_b32 v102, 0
  v_mov_b32 v103, 0
  s_waitcnt vmcnt(7)
  v_dot2_f32_bf16 v96, v40, v8, v96
  v_dot2_f32_bf16 v97, v40, v9, v97
  v_dot2_f32_bf16 v98, v41, v8, v98
  v_dot2_f32_bf16 v99, v41, v9, v99
  v_dot2_f32_bf16 v100, v42, v8, v100
  v_dot2_f32_bf16 v101, v42, v9, v101
  v_dot2_f32_bf16 v102, v43, v8, v102
  v_dot2_f32_bf16 v103, v43, v9, v103
  s_waitcnt vmcnt(6)
  v_dot2_f32_bf16 v96, v44, v8, v96
  v_dot2_f32_bf16 v97, v44, v9, v97
  v_dot2_f32_bf16 v98, v45, v8, v98
  v_dot2_f32_bf16 v99, v45, v9, v99
  v_dot2_f32_bf16 v100, v46, v8, v100
  v_dot2_f32_bf16 v101, v46, v9, v101
  v_dot2_f32_bf16 v102, v47, v8, v102
  v_dot2_f32_bf16 v103, v47, v9, v103
  s_waitcnt vmcnt(5)
  v_dot2_f32_bf16 v96, v48, v8, v96
  v_dot2_f32_bf16 v97, v48, v9, v97
  v_dot2_f32_bf16 v98, v49, v8, v98
  v_dot2_f32_bf16 v99, v49, v9, v99
  v_dot2_f32_bf16 v100, v50, v8, v100
  v_dot2_f32_bf16 v101, v50, v9, v101
  v_dot2_f32_bf16 v102, v51, v8, v102
  v_dot2_f32_bf16 v103, v51, v9, v103
  s_waitcnt vmcnt(4)
  v_dot2_f32_bf16 v96, v52, v8, v96
  v_dot2_f32_bf16 v97, v52, v9, v97
  v_dot2_f32_bf16 v98, v53, v8, v98
  v_dot2_f32_bf16 v99, v53, v9, v99
  v_dot2_f32_bf16 v100, v54, v8, v100
  v_dot2_f32_bf16 v101, v54, v9, v101
  v_dot2_f32_bf16 v102, v55, v8, v102
  v_dot2_f32_bf16 v103, v55, v9, v103
  s_waitcnt vmcnt(3)
  v_dot2_f32_bf16 v96, v56, v8, v96
  v_dot2_f32_bf16 v97, v56, v9, v97
  v_dot2_f32_bf16 v98, v57, v8, v98
  v_dot2_f32_bf16 v99, v57, v9, v99
  v_dot2_f32_bf16 v100, v58, v8, v100
  v_dot2_f32_bf16 v101, v58, v9, v101
  v_dot2_f32_bf16 v102, v59, v8, v102
  v_dot2_f32_bf16 v103, v59, v9, v103
  s_waitcnt vmcnt(2)
  v_dot2_f32_bf16 v96, v60, v8, v96
  v_dot2_f32_bf16 v97, v60, v9, v97
  v_dot2_f32_bf16 v98, v61, v8, v98
  v_dot2_f32_bf16 v99, v61, v9, v99
  v_dot2_f32_bf16 v100, v62, v8, v100
  v_dot2_f32_bf16 v101, v62, v9, v101
  v_dot2_f32_bf16 v102, v63, v8, v102
  v_dot2_f32_bf16 v103, v63, v9, v103
  s_waitcnt vmcnt(1)
  v_dot2_f32_bf16 v96, v64, v8, v96
  v_dot2_f32_bf16 v97, v64, v9, v97
  v_dot2_f32_bf16 v98, v65, v8, v98
  v_dot2_f32_bf16 v99, v65, v9, v99
  v_dot2_f32_bf16 v100, v66, v8, v100
  v_dot2_f32_bf16 v101, v66, v9, v101
  v_dot2_f32_bf16 v102, v67, v8, v102
  v_dot2_f32_bf16 v103, v67, v9, v103
  s_waitcnt vmcnt(0)
  v_dot2_f32_bf16 v96, v68, v8, v96
  v_dot2_f32_bf16 v97, v68, v9, v97
  v_dot2_f32_bf16 v98, v69, v8, v98
  v_dot2_f32_bf16 v99, v69, v9, v99
  v_dot2_f32_bf16 v100, v70, v8, v100
  v_dot2_f32_bf16 v101, v70, v9, v101
  v_dot2_f32_bf16 v102, v71, v8, v102
  v_dot2_f32_bf16 v103, v71, v9, v103
  v_max3_u32 v108, v40, v42, v44
  v_max3_u32 v108, v108, v46, v48
  v_max3_u32 v108, v108, v50, v52
  v_max3_u32 v108, v108, v54, v56
  v_max3_u32 v108, v108, v58, v60
  v_max3_u32 v108, v108, v62, v64
  v_max3_u32 v108, v108, v66, v68
  v_max_u32 v108, v108, v70
  v_cmp_eq_u32 vcc, -1, v108
  s_nop 1
  s_cmp_lg_u64 vcc, 0
  s_cbranch_scc1 L_sr_7
L_sb_8:
  v_cvt_pk_bf16_f32 v104, v96, v97
  v_cvt_pk_bf16_f32 v105, v98, v99
  v_cvt_pk_bf16_f32 v106, v100, v101
  v_cvt_pk_bf16_f32 v107, v102, v103
  ds_write_b64 v193, v[104:105]
  ds_write_b64 v193, v[106:107] offset:16
  s_waitcnt lgkmcnt(0)
  s_barrier
  s_add_u32 m0, s91, 0
  s_add_u32 s68, s90, 0
  buffer_load_dwordx4 v252, s[24:27], s68 offen lds
  s_add_u32 m0, s91, 8192
  s_add_u32 s68, s90, 229376
  buffer_load_dwordx4 v252, s[24:27], s68 offen lds
  ds_read_b128 v[40:43], v192 offset:0
  ds_read_b128 v[44:47], v191 offset:1024
  ds_read_b128 v[48:51], v192 offset:2048
  ds_read_b128 v[52:55], v191 offset:3072
  ds_read_b128 v[56:59], v192 offset:4096
  ds_read_b128 v[60:63], v191 offset:5120
  ds_read_b128 v[64:67], v192 offset:6144
  ds_read_b128 v[68:71], v191 offset:7168
  s_waitcnt lgkmcnt(6)
  v_mfma_f32_16x16x32_bf16 v[176:179], v[40:43], v[196:199], 0
  v_mfma_f32_16x16x32_bf16 v[180:183], v[44:47], v[196:199], 0
  s_waitcnt lgkmcnt(4)
  v_mfma_f32_16x16x32_bf16 v[176:179], v[48:51], v[200:203], v[176:179]
  v_mfma_f32_16x16x32_bf16 v[180:183], v[52:55], v[200:203], v[180:183]
  s_waitcnt lgkmcnt(2)
  v_mfma_f32_16x16x32_bf16 v[176:179], v[56:59], v[196:199], v[176:179]
  v_mfma_f32_16x16x32_bf16 v[180:183], v[60:63], v[196:199], v[180:183]
  s_waitcnt lgkmcnt(0)
  v_mfma_f32_16x16x32_bf16 v[176:179], v[64:67], v[200:203], v[176:179]
  v_mfma_f32_16x16x32_bf16 v[180:183], v[68:71], v[200:203], v[180:183]
  s_nop 7
  v_add_f32 v6, 0x358637bd, v183
  v_rcp_f32 v6, v6
  s_nop 0
  v_mul_f32 v176, v176, v6
  v_mul_f32 v177, v177, v6
  v_mul_f32 v178, v178, v6
  v_mul_f32 v179, v179, v6
  v_mul_f32 v180, v180, v6
  v_mul_f32 v181, v181, v6
  v_mul_f32 v182, v182, v6
  v_cvt_pk_bf16_f32 v184, v176, v177
  v_cvt_pk_bf16_f32 v185, v178, v179
  v_cvt_pk_bf16_f32 v186, v180, v181
  v_cvt_pk_bf16_f32 v187, v182, 0
  buffer_store_dwordx4 v[184:187], v4, s[44:47], s72 offen sc1
  s_lshl_b32 s51, s77, 2
  s_add_u32 s51, s51, s57
  s_mul_i32 s51, s51, 7168
  s_lshl_b32 s52, s76, 8
  s_add_u32 s51, s51, s52
  s_lshl_b32 s52, s58, 7
  s_add_u32 s51, s51, s52
  s_add_u32 s51, s51, s69
  v_and_b32 v9, 7, v1
  s_add_u32 m0, s91, 16384
  s_add_u32 s68, s90, 458752
  buffer_load_dwordx4 v252, s[24:27], s68 offen lds
  v_lshrrev_b32 v10, 3, v1
  v_mul_u32_u24 v5, 896, v10
  v_lshl_add_u32 v5, v9, 4, v5
  s_cmp_ge_u32 s50, 4
  s_mov_b32 s53, 81920
  s_cmov_b32 s53, 153600
  s_add_u32 s53, s53, s91
  s_mov_b32 m0, s53
  v_lshlrev_b32 v198, 7, v9
  buffer_load_dwordx4 v5, s[8:11], s51 offen lds
  v_lshl_add_u32 v198, v10, 4, v198
  v_add_u32 v198, s53, v198
  s_add_u32 m0, s91, 24576
  s_add_u32 s68, s90, 688128
  buffer_load_dwordx4 v252, s[24:27], s68 offen lds
  s_add_u32 m0, s91, 32768
  s_add_u32 s68, s90, 917504
  buffer_load_dwordx4 v252, s[24:27], s68 offen lds
  s_add_u32 m0, s91, 40960
  s_add_u32 s68, s90, 1146880
  buffer_load_dwordx4 v252, s[24:27], s68 offen lds
  s_lshl_b32 s62, s77, 5
  s_lshl_b32 s52, s57, 2
  s_add_u32 s62, s62, s52
  s_lshl_b32 s62, s62, 10
  s_add_u32 s62, s62, 2097152
  s_add_u32 s63, s62, 16384
  s_mul_i32 s51, s57, 18432
  s_mul_i32 s52, s58, 9216
  s_add_u32 s51, s51, s52
  s_add_u32 s51, s51, 83968
  v_lshrrev_b32 v6, 1, v2
  v_mul_u32_u24 v6, 1152, v6
  v_and_b32 v7, 1, v2
  v_lshl_add_u32 v6, v7, 9, v6
  v_lshl_add_u32 v6, v3, 4, v6
  v_add_u32 v196, s51, v6
  s_lshl_b32 s51, s57, 7
  s_add_u32 s51, s51, s52
  s_add_u32 s51, s51, 83968
  v_mul_u32_u24 v6, 1152, v10
  v_lshl_add_u32 v6, v9, 4, v6
  v_add_u32 v197, s51, v6
  v_cmp_gt_u32 vcc, 0x10000, v215
  s_nop 1
  v_cndmask_b32 v8, 0, -1, vcc
  s_lshl_b32 s68, s50, 6
  v_lshlrev_b32 v5, 3, v1
  v_add_u32 v5, s68, v5
  v_mov_b32 v6, 2146435072
  v_cmp_gt_u32 vcc, 8, v1
  s_nop 1
  v_cndmask_b32 v7, v6, v5, vcc
  s_add_u32 m0, s91, 49152
  s_add_u32 s68, s90, 1376256
  buffer_load_dwordx4 v252, s[24:27], s68 offen lds
  v_mov_b32 v10, 0x3f803f80
  s_waitcnt vmcnt(4)
  ds_read_b128 v[176:179], v198
  s_waitcnt lgkmcnt(0)
  v_lshlrev_b32 v180, 16, v176
  v_and_b32 v181, 0xffff0000, v176
  v_lshlrev_b32 v182, 16, v177
  v_and_b32 v183, 0xffff0000, v177
  v_lshlrev_b32 v184, 16, v178
  v_and_b32 v185, 0xffff0000, v178
  v_lshlrev_b32 v186, 16, v179
  v_and_b32 v187, 0xffff0000, v179
  s_barrier
  buffer_load_dwordx4 v[216:219], v4, s[44:47], s62 offen offset:0 sc1
  buffer_load_dwordx4 v[220:223], v4, s[44:47], s63 offen offset:0 sc1
  buffer_load_dwordx4 v[224:227], v4, s[44:47], s62 offen offset:1024 sc1
  buffer_load_dwordx4 v[228:231], v4, s[44:47], s63 offen offset:1024 sc1
  buffer_load_dwordx4 v[232:235], v4, s[44:47], s62 offen offset:2048 sc1
  buffer_load_dwordx4 v[236:239], v4, s[44:47], s63 offen offset:2048 sc1
  buffer_load_dwordx4 v[240:243], v4, s[44:47], s62 offen offset:3072 sc1
  buffer_load_dwordx4 v[244:247], v4, s[44:47], s63 offen offset:3072 sc1
  s_waitcnt vmcnt(7)
  v_mfma_f32_16x16x32_bf16 v[72:75], v[112:115], v[216:219], 0
  v_mfma_f32_16x16x32_bf16 v[76:79], v[116:119], v[216:219], 0
  v_mfma_f32_16x16x32_bf16 v[80:83], v[120:123], v[216:219], 0
  v_mfma_f32_16x16x32_bf16 v[84:87], v[124:127], v[216:219], 0
  s_waitcnt vmcnt(6)
  v_mfma_f32_16x16x32_bf16 v[88:91], v[112:115], v[220:223], 0
  v_mfma_f32_16x16x32_bf16 v[92:95], v[116:119], v[220:223], 0
  v_mfma_f32_16x16x32_bf16 v[96:99], v[120:123], v[220:223], 0
  v_mfma_f32_16x16x32_bf16 v[100:103], v[124:127], v[220:223], 0
  s_waitcnt vmcnt(5)
  v_mfma_f32_16x16x32_bf16 v[72:75], v[128:131], v[224:227], v[72:75]
  v_mfma_f32_16x16x32_bf16 v[76:79], v[132:135], v[224:227], v[76:79]
  v_mfma_f32_16x16x32_bf16 v[80:83], v[136:139], v[224:227], v[80:83]
  v_mfma_f32_16x16x32_bf16 v[84:87], v[140:143], v[224:227], v[84:87]
  s_waitcnt vmcnt(4)
  v_mfma_f32_16x16x32_bf16 v[88:91], v[128:131], v[228:231], v[88:91]
  v_mfma_f32_16x16x32_bf16 v[92:95], v[132:135], v[228:231], v[92:95]
  v_mfma_f32_16x16x32_bf16 v[96:99], v[136:139], v[228:231], v[96:99]
  v_mfma_f32_16x16x32_bf16 v[100:103], v[140:143], v[228:231], v[100:103]
  s_waitcnt vmcnt(3)
  v_mfma_f32_16x16x32_bf16 v[72:75], v[144:147], v[232:235], v[72:75]
  v_mfma_f32_16x16x32_bf16 v[76:79], v[148:151], v[232:235], v[76:79]
  v_mfma_f32_16x16x32_bf16 v[80:83], v[152:155], v[232:235], v[80:83]
  v_mfma_f32_16x16x32_bf16 v[84:87], v[156:159], v[232:235], v[84:87]
  s_waitcnt vmcnt(2)
  v_mfma_f32_16x16x32_bf16 v[88:91], v[144:147], v[236:239], v[88:91]
  v_mfma_f32_16x16x32_bf16 v[92:95], v[148:151], v[236:239], v[92:95]
  v_mfma_f32_16x16x32_bf16 v[96:99], v[152:155], v[236:239], v[96:99]
  v_mfma_f32_16x16x32_bf16 v[100:103], v[156:159], v[236:239], v[100:103]
  s_waitcnt vmcnt(1)
  v_mfma_f32_16x16x32_bf16 v[72:75], v[160:163], v[240:243], v[72:75]
  v_mfma_f32_16x16x32_bf16 v[76:79], v[164:167], v[240:243], v[76:79]
  v_mfma_f32_16x16x32_bf16 v[80:83], v[168:171], v[240:243], v[80:83]
  v_mfma_f32_16x16x32_bf16 v[84:87], v[172:175], v[240:243], v[84:87]
  s_waitcnt vmcnt(0)
  v_mfma_f32_16x16x32_bf16 v[88:91], v[160:163], v[244:247], v[88:91]
  v_mfma_f32_16x16x32_bf16 v[92:95], v[164:167], v[244:247], v[92:95]
  v_mfma_f32_16x16x32_bf16 v[96:99], v[168:171], v[244:247], v[96:99]
  v_mfma_f32_16x16x32_bf16 v[100:103], v[172:175], v[244:247], v[100:103]
  v_max3_u32 v5, v216, v220, v224
  v_max3_u32 v5, v5, v228, v232
  v_max3_u32 v5, v5, v236, v240
  v_max_u32 v5, v5, v244
  v_cmp_eq_u32 vcc, -1, v5
  s_nop 1
  s_cmp_lg_u64 vcc, 0
  s_cbranch_scc1 L_sr_11
L_sb_12:
  ds_write_b128 v196, v[72:75] offset:0
  ds_write_b128 v196, v[76:79] offset:2304
  ds_write_b128 v196, v[80:83] offset:4608
  ds_write_b128 v196, v[84:87] offset:6912
  ds_write_b128 v196, v[88:91] offset:256
  ds_write_b128 v196, v[92:95] offset:2560
  ds_write_b128 v196, v[96:99] offset:4864
  ds_write_b128 v196, v[100:103] offset:7168
  s_lshl_b32 s51, s95, 14
  s_lshl_b32 s52, s58, 13
  s_add_u32 s51, s51, s52
  s_add_u32 s62, s51, 65536
  s_add_u32 s63, s62, 4096
  v_lshlrev_b32 v198, 2, v0
  v_and_b32 v198, 1023, v198
  buffer_load_dword v188, v198, s[44:47], s62 offen offset:0 sc1
  buffer_load_dword v189, v198, s[44:47], s62 offen offset:1024 sc1
  buffer_load_dword v190, v198, s[44:47], s62 offen offset:2048 sc1
  buffer_load_dword v191, v198, s[44:47], s62 offen offset:3072 sc1
  buffer_load_dword v192, v198, s[44:47], s63 offen offset:0 sc1
  buffer_load_dword v193, v198, s[44:47], s63 offen offset:1024 sc1
  buffer_load_dword v194, v198, s[44:47], s63 offen offset:2048 sc1
  buffer_load_dword v195, v198, s[44:47], s63 offen offset:3072 sc1
  s_add_u32 m0, s91, 57344
  s_add_u32 s68, s90, 0
  buffer_load_dwordx4 v252, s[28:31], s68 offen lds
  s_add_u32 m0, s91, 65536
  s_add_u32 s68, s90, 229376
  buffer_load_dwordx4 v252, s[28:31], s68 offen lds
  s_add_u32 m0, s91, 73728
  s_add_u32 s68, s90, 458752
  buffer_load_dwordx4 v252, s[28:31], s68 offen lds
  v_mov_b32 v104, 0
  v_mov_b32 v105, 0
  s_waitcnt lgkmcnt(0)
  s_barrier
  ds_read_b128 v[72:75], v197 offset:0
  ds_read_b128 v[76:79], v197 offset:512
  ds_read_b128 v[80:83], v197 offset:18432
  ds_read_b128 v[84:87], v197 offset:18944
  ds_read_b128 v[88:91], v197 offset:36864
  ds_read_b128 v[92:95], v197 offset:37376
  ds_read_b128 v[96:99], v197 offset:55296
  ds_read_b128 v[100:103], v197 offset:55808
  s_waitcnt lgkmcnt(0)
  v_add_f32 v72, v72, v80
  v_add_f32 v88, v88, v96
  v_add_f32 v73, v73, v81
  v_add_f32 v89, v89, v97
  v_add_f32 v74, v74, v82
  v_add_f32 v90, v90, v98
  v_add_f32 v75, v75, v83
  v_add_f32 v91, v91, v99
  v_add_f32 v76, v76, v84
  v_add_f32 v92, v92, v100
  v_add_f32 v77, v77, v85
  v_add_f32 v93, v93, v101
  v_add_f32 v78, v78, v86
  v_add_f32 v94, v94, v102
  v_add_f32 v79, v79, v87
  v_add_f32 v95, v95, v103
  v_add_f32 v72, v72, v180
  v_add_f32 v73, v73, v181
  v_add_f32 v74, v74, v182
  v_add_f32 v75, v75, v183
  v_add_f32 v76, v76, v184
  v_add_f32 v77, v77, v185
  v_add_f32 v78, v78, v186
  v_add_f32 v79, v79, v187
  v_add_f32 v72, v72, v88
  v_add_f32 v73, v73, v89
  v_add_f32 v74, v74, v90
  v_add_f32 v75, v75, v91
  v_add_f32 v76, v76, v92
  v_add_f32 v77, v77, v93
  v_add_f32 v78, v78, v94
  v_add_f32 v79, v79, v95
  v_cvt_pk_bf16_f32 v108, v72, v73
  v_cvt_pk_bf16_f32 v109, v74, v75
  v_cvt_pk_bf16_f32 v110, v76, v77
  v_cvt_pk_bf16_f32 v111, v78, v79
  buffer_store_dwordx4 v[108:111], v215, s[44:47], s73 offen sc1
  v_dot2_f32_bf16 v104, v108, v10, v104
  v_dot2_f32_bf16 v105, v108, v108, v105
  v_dot2_f32_bf16 v104, v109, v10, v104
  v_dot2_f32_bf16 v105, v109, v109, v105
  v_dot2_f32_bf16 v104, v110, v10, v104
  v_dot2_f32_bf16 v105, v110, v110, v105
  v_dot2_f32_bf16 v104, v111, v10, v104
  v_dot2_f32_bf16 v105, v111, v111, v105
  s_nop 1
  v_and_b32 v104, v8, v104
  v_and_b32 v105, v8, v105
  s_nop 0
  v_add_f32_dpp v104, v104, v104 row_ror:8 row_mask:0xf bank_mask:0xf
  v_add_f32_dpp v105, v105, v105 row_ror:8 row_mask:0xf bank_mask:0xf
  v_mov_b32 v106, v104
  v_mov_b32 v107, v105
  s_nop 0
  v_permlane16_swap_b32 v104, v106
  v_permlane16_swap_b32 v105, v107
  v_add_f32 v104, v104, v106
  v_add_f32 v105, v105, v107
  v_mov_b32 v106, v104
  v_mov_b32 v107, v105
  s_nop 0
  v_permlane32_swap_b32 v104, v106
  v_permlane32_swap_b32 v105, v107
  v_add_f32 v104, v104, v106
  v_add_f32 v105, v105, v107
  buffer_store_dwordx2 v[104:105], v7, s[44:47], s74 offen sc1
  s_waitcnt vmcnt(5)
  v_max3_u32 v5, v188, v189, v190
  v_max3_u32 v5, v5, v191, v192
  v_max3_u32 v5, v5, v193, v194
  v_max_u32 v5, v5, v195
  v_cmp_eq_u32 vcc, -1, v5
  s_nop 1
  s_cmp_lg_u64 vcc, 0
  s_cbranch_scc1 L_sr_15
L_sb_16:
  v_add_f32 v188, v188, v192
  v_add_f32 v189, v189, v193
  v_add_f32 v190, v190, v194
  v_add_f32 v191, v191, v195
  v_add_f32 v188, v188, v190
  v_add_f32 v189, v189, v191
  v_add_f32 v188, v188, v189
  v_lshlrev_b32 v198, 2, v0
  v_add_u32 v198, 157696, v198
  ds_write_b32 v198, v188
  s_waitcnt lgkmcnt(0)
  s_barrier
  s_cmp_ge_u32 s95, 14
  s_cbranch_scc1 L_end
  s_add_u32 m0, s91, 81920
  s_add_u32 s52, s90, 688128
  buffer_load_dwordx4 v252, s[28:31], s52 offen lds
  s_add_u32 m0, s91, 90112
  s_add_u32 s52, s90, 917504
  buffer_load_dwordx4 v252, s[28:31], s52 offen lds
  s_add_u32 m0, s91, 98304
  s_add_u32 s52, s90, 1146880
  buffer_load_dwordx4 v252, s[28:31], s52 offen lds
  s_add_u32 m0, s91, 106496
  s_add_u32 s52, s90, 1376256
  buffer_load_dwordx4 v252, s[28:31], s52 offen lds
  s_mul_i32 s4, s50, 5120
  s_lshl_b32 s5, s50, 11
  s_mul_i32 s6, s50, 3072
  s_lshl_b32 s83, s50, 12
  s_add_u32 m0, s91, 114688
  s_add_u32 s52, s90, 128
  buffer_load_dwordx4 v252, s[24:27], s52 offen lds
  s_add_u32 m0, s91, 122880
  s_add_u32 s52, s90, 229504
  buffer_load_dwordx4 v252, s[24:27], s52 offen lds
  s_add_u32 m0, s91, 131072
  s_add_u32 s52, s90, 458880
  buffer_load_dwordx4 v252, s[24:27], s52 offen lds
  s_add_u32 m0, s91, 139264
  s_add_u32 s52, s90, 688256
  buffer_load_dwordx4 v252, s[24:27], s52 offen lds
  s_add_u32 m0, s91, 147456
  s_add_u32 s52, s90, 917632
  buffer_load_dwordx4 v252, s[24:27], s52 offen lds
  s_lshl_b32 s61, s93, 2
  s_lshl_b32 s51, s64, 1
  s_add_u32 s61, s61, s51
  s_lshl_b32 s63, s79, 11
  s_add_u32 s63, s63, 327680
  s_mul_i32 s89, s79, 28672
  s_add_u32 s89, s89, 4194304
  s_mul_i32 s7, s61, 114688
  s_lshl_b32 s52, s67, 10
  s_add_u32 s7, s7, s52
  s_add_u32 s7, s7, 6291456
  s_add_u32 s51, s65, 0
  s_sub_u32 s52, s51, 7
  s_cmp_ge_u32 s51, 7
  s_cselect_b32 s51, s52, s51
  s_mul_i32 s52, s51, 114688
  s_add_u32 s12, s80, s52
  s_lshl_b32 s52, s51, 13
  s_add_u32 s19, s7, s52
  s_add_u32 s51, s65, 1
  s_sub_u32 s52, s51, 7
  s_cmp_ge_u32 s51, 7
  s_cselect_b32 s51, s52, s51
  s_mul_i32 s52, s51, 114688
  s_add_u32 s13, s80, s52
  s_lshl_b32 s52, s51, 13
  s_add_u32 s20, s7, s52
  s_add_u32 s51, s65, 2
  s_sub_u32 s52, s51, 7
  s_cmp_ge_u32 s51, 7
  s_cselect_b32 s51, s52, s51
  s_mul_i32 s52, s51, 114688
  s_add_u32 s14, s80, s52
  s_lshl_b32 s52, s51, 13
  s_add_u32 s21, s7, s52
  s_add_u32 s51, s65, 3
  s_sub_u32 s52, s51, 7
  s_cmp_ge_u32 s51, 7
  s_cselect_b32 s51, s52, s51
  s_mul_i32 s52, s51, 114688
  s_add_u32 s15, s80, s52
  s_lshl_b32 s52, s51, 13
  s_add_u32 s22, s7, s52
  s_add_u32 s51, s65, 4
  s_sub_u32 s52, s51, 7
  s_cmp_ge_u32 s51, 7
  s_cselect_b32 s51, s52, s51
  s_mul_i32 s52, s51, 114688
  s_add_u32 s16, s80, s52
  s_lshl_b32 s52, s51, 13
  s_add_u32 s23, s7, s52
  s_add_u32 s51, s65, 5
  s_sub_u32 s52, s51, 7
  s_cmp_ge_u32 s51, 7
  s_cselect_b32 s51, s52, s51
  s_mul_i32 s52, s51, 114688
  s_add_u32 s17, s80, s52
  s_lshl_b32 s52, s51, 13
  s_add_u32 s81, s7, s52
  s_add_u32 s51, s65, 6
  s_sub_u32 s52, s51, 7
  s_cmp_ge_u32 s51, 7
  s_cselect_b32 s51, s52, s51
  s_mul_i32 s52, s51, 114688
  s_add_u32 s18, s80, s52
  s_lshl_b32 s52, s51, 13
  s_add_u32 s82, s7, s52
  v_bfe_u32 v5, v1, 2, 2
  v_lshl_add_u32 v6, v254, 3, v5
  v_lshlrev_b32 v6, 7, v6
  v_lshrrev_b32 v5, 1, v5
  v_xor_b32 v5, s58, v5
  v_lshl_add_u32 v6, v5, 6, v6
  v_and_b32 v7, 1, v2
  v_lshl_add_u32 v6, v7, 5, v6
  v_and_b32 v7, 3, v1
  v_lshl_add_u32 v240, v7, 3, v6
  v_add_u32 v241, 57344, v240
  v_add_u32 v15, 114688, v240
  s_lshl_b32 s51, s58, 7
  s_add_u32 s51, s51, 161792
  v_lshlrev_b32 v242, 4, v254
  v_add_u32 v242, s51, v242
  v_mov_b32 v243, 162816
  v_lshlrev_b32 v8, 3, v1
  v_lshlrev_b32 v5, 2, v0
  v_and_b32 v5, 1023, v5
  v_add_u32 v5, 157696, v5
  ds_read2st64_b32 v[72:73], v5 offset0:0 offset1:4
  s_waitcnt lgkmcnt(0)
  v_add_f32 v72, v72, v73
  ds_write_b32 v5, v72 offset:4096
  s_mov_b32 s56, 0
L_dp_19:
  buffer_load_dwordx2 v[128:129], v8, s[44:47], s63 offen offset:0 sc1
  buffer_load_dwordx2 v[130:131], v8, s[44:47], s63 offen offset:512 sc1
  buffer_load_dwordx2 v[132:133], v8, s[44:47], s63 offen offset:1024 sc1
  buffer_load_dwordx2 v[134:135], v8, s[44:47], s63 offen offset:1536 sc1
  s_waitcnt vmcnt(0)
  v_max3_u32 v6, v128, v130, v132
  v_max_u32 v6, v6, v134
  v_cmp_eq_u32 vcc, -1, v6
  s_add_u32 s56, s56, 1
  s_cmp_ge_u32 s56, 200000
  s_cbranch_scc1 L_dpd_20
  s_cmp_lg_u64 vcc, 0
  s_cbranch_scc1 L_dp_19
L_dpd_20:
  s_add_u32 s51, s89, 0
  buffer_load_dwordx4 v[16:19], v4, s[44:47], s51 offen offset:0 sc1
  buffer_load_dwordx4 v[20:23], v4, s[44:47], s51 offen offset:1024 sc1
  buffer_load_dwordx4 v[24:27], v4, s[44:47], s51 offen offset:2048 sc1
  buffer_load_dwordx4 v[28:31], v4, s[44:47], s51 offen offset:3072 sc1
  s_add_u32 s51, s89, 4096
  buffer_load_dwordx4 v[32:35], v4, s[44:47], s51 offen offset:0 sc1
  buffer_load_dwordx4 v[36:39], v4, s[44:47], s51 offen offset:1024 sc1
  buffer_load_dwordx4 v[40:43], v4, s[44:47], s51 offen offset:2048 sc1
  buffer_load_dwordx4 v[44:47], v4, s[44:47], s51 offen offset:3072 sc1
  s_waitcnt lgkmcnt(0)
  s_barrier
  v_add_f32 v244, v128, v132
  v_add_f32 v245, v129, v133
  v_add_f32 v246, v130, v134
  v_add_f32 v247, v131, v135
  v_add_f32 v244, v244, v246
  v_add_f32 v245, v245, v247
  v_mov_b32 v246, v244
  v_mov_b32 v247, v245
  s_nop 0
  v_permlane32_swap_b32 v244, v246
  v_permlane32_swap_b32 v245, v247
  v_add_f32 v244, v244, v246
  v_add_f32 v245, v245, v247
  v_mul_f32 v251, 0xbb124925, v244
  v_mul_f32 v245, 0x3b124925, v245
  v_fma_f32 v245, -v251, v251, v245
  v_max_f32 v245, 0, v245
  v_add_f32 v250, 0x3727c5ac, v245
  v_rsq_f32 v244, v250
  s_nop 0
  v_mul_f32 v248, 0xc0135761, v244
  v_mul_f32 v245, v244, v244
  v_mul_f32 v245, v245, v244
  v_mul_f32 v249, 0xbdd2d3e8, v245
  ds_read_b64_tr_b16 v[208:209], v240 offset:0
  ds_read_b64_tr_b16 v[210:211], v240 offset:512
  ds_read_b64_tr_b16 v[212:213], v241 offset:0
  ds_read_b64_tr_b16 v[214:215], v241 offset:512
  ds_read_b64_tr_b16 v[216:217], v240 offset:2048
  ds_read_b64_tr_b16 v[218:219], v240 offset:2560
  ds_read_b64_tr_b16 v[220:221], v241 offset:2048
  ds_read_b64_tr_b16 v[222:223], v241 offset:2560
  ds_read_b64_tr_b16 v[224:225], v240 offset:4096
  ds_read_b64_tr_b16 v[226:227], v240 offset:4608
  s_setprio 3
  s_waitcnt vmcnt(4)
  v_max3_u32 v6, v16, v20, v24
  v_max_u32 v6, v6, v28
  v_cmp_eq_u32 vcc, -1, v6
  s_nop 1
  s_cmp_lg_u64 vcc, 0
  s_cbranch_scc1 L_hr_33
L_hb_34:
  s_waitcnt lgkmcnt(8)
  v_mfma_f32_32x32x16_bf16 v[128:143], v[208:211], v[16:19], 0
  s_add_u32 s51, s89, 8192
  buffer_load_dwordx4 v[48:51], v4, s[44:47], s51 offen offset:0 sc1
  ds_read_b64_tr_b16 v[208:209], v241 offset:4096
  ds_read_b64_tr_b16 v[210:211], v241 offset:4608
  s_waitcnt lgkmcnt(8)
  v_mfma_f32_32x32x16_bf16 v[144:159], v[212:215], v[16:19], 0
  buffer_load_dwordx4 v[52:55], v4, s[44:47], s51 offen offset:1024 sc1
  ds_read_b64_tr_b16 v[212:213], v240 offset:6144
  ds_read_b64_tr_b16 v[214:215], v240 offset:6656
  s_waitcnt lgkmcnt(8)
  v_mfma_f32_32x32x16_bf16 v[128:143], v[216:219], v[20:23], v[128:143]
  buffer_load_dwordx4 v[56:59], v4, s[44:47], s51 offen offset:2048 sc1
  ds_read_b64_tr_b16 v[216:217], v241 offset:6144
  ds_read_b64_tr_b16 v[218:219], v241 offset:6656
  s_waitcnt lgkmcnt(8)
  v_mfma_f32_32x32x16_bf16 v[144:159], v[220:223], v[20:23], v[144:159]
  buffer_load_dwordx4 v[60:63], v4, s[44:47], s51 offen offset:3072 sc1
  ds_read_b64_tr_b16 v[220:221], v240 offset:8192
  ds_read_b64_tr_b16 v[222:223], v240 offset:8704
  s_waitcnt lgkmcnt(8)
  v_mfma_f32_32x32x16_bf16 v[128:143], v[224:227], v[24:27], v[128:143]
  s_add_u32 s51, s89, 12288
  buffer_load_dwordx4 v[64:67], v4, s[44:47], s51 offen offset:0 sc1
  ds_read_b64_tr_b16 v[224:225], v241 offset:8192
  ds_read_b64_tr_b16 v[226:227], v241 offset:8704
  s_waitcnt lgkmcnt(8)
  v_mfma_f32_32x32x16_bf16 v[144:159], v[208:211], v[24:27], v[144:159]
  buffer_load_dwordx4 v[68:71], v4, s[44:47], s51 offen offset:1024 sc1
  ds_read_b64_tr_b16 v[208:209], v240 offset:10240
  ds_read_b64_tr_b16 v[210:211], v240 offset:10752
  s_waitcnt lgkmcnt(8)
  v_mfma_f32_32x32x16_bf16 v[128:143], v[212:215], v[28:31], v[128:143]
  buffer_load_dwordx4 v[72:75], v4, s[44:47], s51 offen offset:2048 sc1
  ds_read_b64_tr_b16 v[212:213], v241 offset:10240
  ds_read_b64_tr_b16 v[214:215], v241 offset:10752
  s_waitcnt lgkmcnt(8)
  v_mfma_f32_32x32x16_bf16 v[144:159], v[216:219], v[28:31], v[144:159]
  buffer_load_dwordx4 v[76:79], v4, s[44:47], s51 offen offset:3072 sc1
  ds_read_b64_tr_b16 v[216:217], v240 offset:12288
  ds_read_b64_tr_b16 v[218:219], v240 offset:12800
  s_waitcnt vmcnt(8)
  v_max3_u32 v6, v32, v36, v40
  v_max_u32 v6, v6, v44
  v_cmp_eq_u32 vcc, -1, v6
  s_nop 1
  s_cmp_lg_u64 vcc, 0
  s_cbranch_scc1 L_hr_37
L_hb_38:
  s_waitcnt lgkmcnt(8)
  v_mfma_f32_32x32x16_bf16 v[128:143], v[220:223], v[32:35], v[128:143]
  s_add_u32 s51, s89, 16384
  buffer_load_dwordx4 v[80:83], v4, s[44:47], s51 offen offset:0 sc1
  ds_read_b64_tr_b16 v[220:221], v241 offset:12288
  ds_read_b64_tr_b16 v[222:223], v241 offset:12800
  s_waitcnt lgkmcnt(8)
  v_mfma_f32_32x32x16_bf16 v[144:159], v[224:227], v[32:35], v[144:159]
  buffer_load_dwordx4 v[84:87], v4, s[44:47], s51 offen offset:1024 sc1
  ds_read_b64_tr_b16 v[224:225], v240 offset:14336
  ds_read_b64_tr_b16 v[226:227], v240 offset:14848
  s_waitcnt lgkmcnt(8)
  v_mfma_f32_32x32x16_bf16 v[128:143], v[208:211], v[36:39], v[128:143]
  buffer_load_dwordx4 v[88:91], v4, s[44:47], s51 offen offset:2048 sc1
  ds_read_b64_tr_b16 v[208:209], v241 offset:14336
  ds_read_b64_tr_b16 v[210:211], v241 offset:14848
  s_waitcnt lgkmcnt(8)
  v_mfma_f32_32x32x16_bf16 v[144:159], v[212:215], v[36:39], v[144:159]
  buffer_load_dwordx4 v[92:95], v4, s[44:47], s51 offen offset:3072 sc1
  ds_read_b64_tr_b16 v[212:213], v240 offset:16384
  ds_read_b64_tr_b16 v[214:215], v240 offset:16896
  s_waitcnt lgkmcnt(8)
  v_mfma_f32_32x32x16_bf16 v[128:143], v[216:219], v[40:43], v[128:143]
  s_add_u32 s51, s89, 20480
  buffer_load_dwordx4 v[96:99], v4, s[44:47], s51 offen offset:0 sc1
  ds_read_b64_tr_b16 v[216:217], v241 offset:16384
  ds_read_b64_tr_b16 v[218:219], v241 offset:16896
  s_waitcnt lgkmcnt(8)
  v_mfma_f32_32x32x16_bf16 v[144:159], v[220:223], v[40:43], v[144:159]
  buffer_load_dwordx4 v[100:103], v4, s[44:47], s51 offen offset:1024 sc1
  ds_read_b64_tr_b16 v[220:221], v240 offset:18432
  ds_read_b64_tr_b16 v[222:223], v240 offset:18944
  s_waitcnt lgkmcnt(8)
  v_mfma_f32_32x32x16_bf16 v[128:143], v[224:227], v[44:47], v[128:143]
  buffer_load_dwordx4 v[104:107], v4, s[44:47], s51 offen offset:2048 sc1
  ds_read_b64_tr_b16 v[224:225], v241 offset:18432
  ds_read_b64_tr_b16 v[226:227], v241 offset:18944
  s_waitcnt lgkmcnt(8)
  v_mfma_f32_32x32x16_bf16 v[144:159], v[208:211], v[44:47], v[144:159]
  buffer_load_dwordx4 v[108:111], v4, s[44:47], s51 offen offset:3072 sc1
  ds_read_b64_tr_b16 v[208:209], v240 offset:20480
  ds_read_b64_tr_b16 v[210:211], v240 offset:20992
  s_waitcnt vmcnt(12)
  v_max3_u32 v6, v48, v52, v56
  v_max_u32 v6, v6, v60
  v_cmp_eq_u32 vcc, -1, v6
  s_nop 1
  s_cmp_lg_u64 vcc, 0
  s_cbranch_scc1 L_hr_41
L_hb_42:
  s_waitcnt lgkmcnt(8)
  v_mfma_f32_32x32x16_bf16 v[128:143], v[212:215], v[48:51], v[128:143]
  s_add_u32 s51, s89, 24576
  buffer_load_dwordx4 v[112:115], v4, s[44:47], s51 offen offset:0 sc1
  ds_read_b64_tr_b16 v[212:213], v241 offset:20480
  ds_read_b64_tr_b16 v[214:215], v241 offset:20992
  s_waitcnt lgkmcnt(8)
  v_mfma_f32_32x32x16_bf16 v[144:159], v[216:219], v[48:51], v[144:159]
  buffer_load_dwordx4 v[116:119], v4, s[44:47], s51 offen offset:1024 sc1
  ds_read_b64_tr_b16 v[216:217], v240 offset:22528
  ds_read_b64_tr_b16 v[218:219], v240 offset:23040
  s_waitcnt lgkmcnt(8)
  v_mfma_f32_32x32x16_bf16 v[128:143], v[220:223], v[52:55], v[128:143]
  buffer_load_dwordx4 v[120:123], v4, s[44:47], s51 offen offset:2048 sc1
  ds_read_b64_tr_b16 v[220:221], v241 offset:22528
  ds_read_b64_tr_b16 v[222:223], v241 offset:23040
  s_waitcnt lgkmcnt(8)
  v_mfma_f32_32x32x16_bf16 v[144:159], v[224:227], v[52:55], v[144:159]
  buffer_load_dwordx4 v[124:127], v4, s[44:47], s51 offen offset:3072 sc1
  ds_read_b64_tr_b16 v[224:225], v240 offset:24576
  ds_read_b64_tr_b16 v[226:227], v240 offset:25088
  s_waitcnt lgkmcnt(8)
  v_mfma_f32_32x32x16_bf16 v[128:143], v[208:211], v[56:59], v[128:143]
  ds_read_b64_tr_b16 v[208:209], v241 offset:24576
  ds_read_b64_tr_b16 v[210:211], v241 offset:25088
  s_waitcnt lgkmcnt(8)
  v_mfma_f32_32x32x16_bf16 v[144:159], v[212:215], v[56:59], v[144:159]
  ds_read_b64_tr_b16 v[212:213], v240 offset:26624
  ds_read_b64_tr_b16 v[214:215], v240 offset:27136
  s_waitcnt lgkmcnt(8)
  v_mfma_f32_32x32x16_bf16 v[128:143], v[216:219], v[60:63], v[128:143]
  ds_read_b64_tr_b16 v[216:217], v241 offset:26624
  ds_read_b64_tr_b16 v[218:219], v241 offset:27136
  s_waitcnt lgkmcnt(8)
  v_mfma_f32_32x32x16_bf16 v[144:159], v[220:223], v[60:63], v[144:159]
  ds_read_b64_tr_b16 v[220:221], v240 offset:28672
  ds_read_b64_tr_b16 v[222:223], v240 offset:29184
  s_waitcnt vmcnt(12)
  v_max3_u32 v6, v64, v68, v72
  v_max_u32 v6, v6, v76
  v_cmp_eq_u32 vcc, -1, v6
  s_nop 1
  s_cmp_lg_u64 vcc, 0
  s_cbranch_scc1 L_hr_45
L_hb_46:
  s_waitcnt lgkmcnt(8)
  v_mfma_f32_32x32x16_bf16 v[128:143], v[224:227], v[64:67], v[128:143]
  ds_read_b64_tr_b16 v[224:225], v241 offset:28672
  ds_read_b64_tr_b16 v[226:227], v241 offset:29184
  s_waitcnt lgkmcnt(8)
  v_mfma_f32_32x32x16_bf16 v[144:159], v[208:211], v[64:67], v[144:159]
  ds_read_b64_tr_b16 v[208:209], v240 offset:30720
  ds_read_b64_tr_b16 v[210:211], v240 offset:31232
  s_waitcnt lgkmcnt(8)
  v_mfma_f32_32x32x16_bf16 v[128:143], v[212:215], v[68:71], v[128:143]
  ds_read_b64_tr_b16 v[212:213], v241 offset:30720
  ds_read_b64_tr_b16 v[214:215], v241 offset:31232
  s_waitcnt lgkmcnt(8)
  v_mfma_f32_32x32x16_bf16 v[144:159], v[216:219], v[68:71], v[144:159]
  ds_read_b64_tr_b16 v[216:217], v240 offset:32768
  ds_read_b64_tr_b16 v[218:219], v240 offset:33280
  s_setprio 2
  s_waitcnt lgkmcnt(8)
  v_mfma_f32_32x32x16_bf16 v[128:143], v[220:223], v[72:75], v[128:143]
  ds_read_b64_tr_b16 v[220:221], v241 offset:32768
  ds_read_b64_tr_b16 v[222:223], v241 offset:33280
  s_waitcnt lgkmcnt(8)
  v_mfma_f32_32x32x16_bf16 v[144:159], v[224:227], v[72:75], v[144:159]
  ds_read_b64_tr_b16 v[224:225], v240 offset:34816
  ds_read_b64_tr_b16 v[226:227], v240 offset:35328
  s_waitcnt lgkmcnt(8)
  v_mfma_f32_32x32x16_bf16 v[128:143], v[208:211], v[76:79], v[128:143]
  ds_read_b64_tr_b16 v[208:209], v241 offset:34816
  ds_read_b64_tr_b16 v[210:211], v241 offset:35328
  s_waitcnt lgkmcnt(8)
  v_mfma_f32_32x32x16_bf16 v[144:159], v[212:215], v[76:79], v[144:159]
  ds_read_b64_tr_b16 v[212:213], v240 offset:36864
  ds_read_b64_tr_b16 v[214:215], v240 offset:37376
  s_waitcnt vmcnt(8)
  v_max3_u32 v6, v80, v84, v88
  v_max_u32 v6, v6, v92
  v_cmp_eq_u32 vcc, -1, v6
  s_nop 1
  s_cmp_lg_u64 vcc, 0
  s_cbranch_scc1 L_hr_49
L_hb_50:
  s_waitcnt lgkmcnt(8)
  v_mfma_f32_32x32x16_bf16 v[128:143], v[216:219], v[80:83], v[128:143]
  ds_read_b64_tr_b16 v[216:217], v241 offset:36864
  ds_read_b64_tr_b16 v[218:219], v241 offset:37376
  s_waitcnt lgkmcnt(8)
  v_mfma_f32_32x32x16_bf16 v[144:159], v[220:223], v[80:83], v[144:159]
  ds_read_b64_tr_b16 v[220:221], v240 offset:38912
  ds_read_b64_tr_b16 v[222:223], v240 offset:39424
  s_waitcnt lgkmcnt(8)
  v_mfma_f32_32x32x16_bf16 v[128:143], v[224:227], v[84:87], v[128:143]
  ds_read_b64_tr_b16 v[224:225], v241 offset:38912
  ds_read_b64_tr_b16 v[226:227], v241 offset:39424
  s_waitcnt lgkmcnt(8)
  v_mfma_f32_32x32x16_bf16 v[144:159], v[208:211], v[84:87], v[144:159]
  ds_read_b64_tr_b16 v[208:209], v240 offset:40960
  ds_read_b64_tr_b16 v[210:211], v240 offset:41472
  s_waitcnt lgkmcnt(8)
  v_mfma_f32_32x32x16_bf16 v[128:143], v[212:215], v[88:91], v[128:143]
  ds_read_b64_tr_b16 v[212:213], v241 offset:40960
  ds_read_b64_tr_b16 v[214:215], v241 offset:41472
  s_waitcnt lgkmcnt(8)
  v_mfma_f32_32x32x16_bf16 v[144:159], v[216:219], v[88:91], v[144:159]
  ds_read_b64_tr_b16 v[216:217], v240 offset:43008
  ds_read_b64_tr_b16 v[218:219], v240 offset:43520
  s_waitcnt lgkmcnt(8)
  v_mfma_f32_32x32x16_bf16 v[128:143], v[220:223], v[92:95], v[128:143]
  ds_read_b64_tr_b16 v[220:221], v241 offset:43008
  ds_read_b64_tr_b16 v[222:223], v241 offset:43520
  s_waitcnt lgkmcnt(8)
  v_mfma_f32_32x32x16_bf16 v[144:159], v[224:227], v[92:95], v[144:159]
  ds_read_b64_tr_b16 v[224:225], v240 offset:45056
  ds_read_b64_tr_b16 v[226:227], v240 offset:45568
  s_waitcnt vmcnt(4)
  v_max3_u32 v6, v96, v100, v104
  v_max_u32 v6, v6, v108
  v_cmp_eq_u32 vcc, -1, v6
  s_nop 1
  s_cmp_lg_u64 vcc, 0
  s_cbranch_scc1 L_hr_53
L_hb_54:
  s_waitcnt lgkmcnt(8)
  v_mfma_f32_32x32x16_bf16 v[128:143], v[208:211], v[96:99], v[128:143]
  s_mov_b64 exec, 1
  ds_add_u32 v243, v12 offset:0
  s_mov_b64 exec, -1
  ds_read_b64_tr_b16 v[208:209], v241 offset:45056
  ds_read_b64_tr_b16 v[210:211], v241 offset:45568
  s_waitcnt lgkmcnt(9)
  v_mfma_f32_32x32x16_bf16 v[144:159], v[212:215], v[96:99], v[144:159]
  ds_read_b64_tr_b16 v[212:213], v240 offset:47104
  ds_read_b64_tr_b16 v[214:215], v240 offset:47616
  s_waitcnt lgkmcnt(9)
  v_mfma_f32_32x32x16_bf16 v[128:143], v[216:219], v[100:103], v[128:143]
  ds_read_b32 v11, v243 offset:0
  ds_read_b64_tr_b16 v[216:217], v241 offset:47104
  ds_read_b64_tr_b16 v[218:219], v241 offset:47616
  s_waitcnt lgkmcnt(10)
  v_mfma_f32_32x32x16_bf16 v[144:159], v[220:223], v[100:103], v[144:159]
  s_waitcnt lgkmcnt(2)
  v_readfirstlane_b32 s55, v11
  s_nop 1
  s_cmp_lt_u32 s55, 8
  s_cbranch_scc1 L_cr_21
L_cb_22:
  s_add_u32 m0, s91, 0
  s_add_u32 s52, s90, 1147008
  buffer_load_dwordx4 v252, s[24:27], s52 offen lds
  ds_read_b64_tr_b16 v[220:221], v240 offset:49152
  ds_read_b64_tr_b16 v[222:223], v240 offset:49664
  v_mfma_f32_32x32x16_bf16 v[128:143], v[224:227], v[104:107], v[128:143]
  ds_read_b64_tr_b16 v[224:225], v241 offset:49152
  ds_read_b64_tr_b16 v[226:227], v241 offset:49664
  v_mfma_f32_32x32x16_bf16 v[144:159], v[208:211], v[104:107], v[144:159]
  s_add_u32 m0, s91, 8192
  s_add_u32 s52, s90, 1376384
  buffer_load_dwordx4 v252, s[24:27], s52 offen lds
  ds_read_b64_tr_b16 v[208:209], v240 offset:51200
  ds_read_b64_tr_b16 v[210:211], v240 offset:51712
  v_mfma_f32_32x32x16_bf16 v[128:143], v[212:215], v[108:111], v[128:143]
  ds_read_b64_tr_b16 v[212:213], v241 offset:51200
  ds_read_b64_tr_b16 v[214:215], v241 offset:51712
  s_waitcnt lgkmcnt(8)
  v_mfma_f32_32x32x16_bf16 v[144:159], v[216:219], v[108:111], v[144:159]
  s_add_u32 m0, s91, 16384
  s_add_u32 s52, s90, 128
  buffer_load_dwordx4 v252, s[28:31], s52 offen lds
  ds_read_b64_tr_b16 v[216:217], v240 offset:53248
  ds_read_b64_tr_b16 v[218:219], v240 offset:53760
  s_waitcnt vmcnt(3)
  v_max3_u32 v6, v112, v116, v120
  v_max_u32 v6, v6, v124
  v_cmp_eq_u32 vcc, -1, v6
  s_nop 1
  s_cmp_lg_u64 vcc, 0
  s_cbranch_scc1 L_hr_57
L_hb_58:
  s_waitcnt lgkmcnt(8)
  v_mfma_f32_32x32x16_bf16 v[128:143], v[220:223], v[112:115], v[128:143]
  ds_read_b64_tr_b16 v[220:221], v241 offset:53248
  ds_read_b64_tr_b16 v[222:223], v241 offset:53760
  s_waitcnt lgkmcnt(8)
  v_mfma_f32_32x32x16_bf16 v[144:159], v[224:227], v[112:115], v[144:159]
  s_add_u32 m0, s91, 24576
  s_add_u32 s52, s90, 229504
  buffer_load_dwordx4 v252, s[28:31], s52 offen lds
  ds_read_b64_tr_b16 v[224:225], v240 offset:55296
  ds_read_b64_tr_b16 v[226:227], v240 offset:55808
  s_waitcnt lgkmcnt(8)
  v_mfma_f32_32x32x16_bf16 v[128:143], v[208:211], v[116:119], v[128:143]
  ds_read_b64_tr_b16 v[208:209], v241 offset:55296
  ds_read_b64_tr_b16 v[210:211], v241 offset:55808
  s_waitcnt lgkmcnt(8)
  v_mfma_f32_32x32x16_bf16 v[144:159], v[212:215], v[116:119], v[144:159]
  s_add_u32 m0, s91, 32768
  s_add_u32 s52, s90, 458880
  buffer_load_dwordx4 v252, s[28:31], s52 offen lds
  ds_read_b64_tr_b16 v[212:213], v15 offset:0
  ds_read_b64_tr_b16 v[214:215], v15 offset:512
  s_waitcnt lgkmcnt(8)
  v_mfma_f32_32x32x16_bf16 v[128:143], v[216:219], v[120:123], v[128:143]
  ds_read_b64_tr_b16 v[216:217], v15 offset:2048
  ds_read_b64_tr_b16 v[218:219], v15 offset:2560
  s_waitcnt lgkmcnt(8)
  v_mfma_f32_32x32x16_bf16 v[144:159], v[220:223], v[120:123], v[144:159]
  s_add_u32 m0, s91, 57344
  s_add_u32 s52, s90, 688256
  buffer_load_dwordx4 v252, s[28:31], s52 offen lds
  ds_read_b64_tr_b16 v[220:221], v15 offset:4096
  ds_read_b64_tr_b16 v[222:223], v15 offset:4608
  s_waitcnt lgkmcnt(8)
  v_mfma_f32_32x32x16_bf16 v[128:143], v[224:227], v[124:127], v[128:143]
  ds_read_b128 v[176:179], v242 offset:0
  ds_read_b128 v[180:183], v242 offset:32
  ds_read_b128 v[184:187], v242 offset:64
  ds_read_b128 v[188:191], v242 offset:96
  ds_read_b64_tr_b16 v[224:225], v15 offset:6144
  ds_read_b64_tr_b16 v[226:227], v15 offset:6656
  s_waitcnt lgkmcnt(12)
  v_mfma_f32_32x32x16_bf16 v[144:159], v[208:211], v[124:127], v[144:159]
  s_add_u32 m0, s91, 65536
  s_add_u32 s52, s90, 917632
  buffer_load_dwordx4 v252, s[28:31], s52 offen lds
  ds_read_b128 v[192:195], v242 offset:512
  ds_read_b128 v[196:199], v242 offset:544
  ds_read_b128 v[200:203], v242 offset:576
  ds_read_b128 v[204:207], v242 offset:608
  ds_read_b64_tr_b16 v[208:209], v15 offset:8192
  ds_read_b64_tr_b16 v[210:211], v15 offset:8704
  s_setprio 1
  s_waitcnt lgkmcnt(15)
  v_mfma_f32_32x32x16_bf16 v[160:175], v[212:215], v[16:19], 0
  s_mov_b64 exec, 1
  ds_add_u32 v243, v12 offset:8
  s_mov_b64 exec, -1
  ds_read_b64_tr_b16 v[212:213], v15 offset:10240
  ds_read_b64_tr_b16 v[214:215], v15 offset:10752
  s_waitcnt lgkmcnt(15)
  v_mfma_f32_32x32x16_bf16 v[160:175], v[216:219], v[20:23], v[160:175]
  s_add_u32 m0, s91, 73728
  s_add_u32 s52, s90, 1147008
  buffer_load_dwordx4 v252, s[28:31], s52 offen lds
  s_waitcnt lgkmcnt(5)
  v_fmac_f32 v128, v251, v176
  v_fmac_f32 v129, v251, v177
  v_fmac_f32 v130, v251, v178
  v_fmac_f32 v131, v251, v179
  ds_read_b64_tr_b16 v[216:217], v15 offset:12288
  ds_read_b64_tr_b16 v[218:219], v15 offset:12800
  v_mfma_f32_32x32x16_bf16 v[160:175], v[220:223], v[24:27], v[160:175]
  v_fmac_f32 v132, v251, v180
  v_fmac_f32 v133, v251, v181
  v_fmac_f32 v134, v251, v182
  v_fmac_f32 v135, v251, v183
  ds_read_b64_tr_b16 v[220:221], v15 offset:14336
  ds_read_b64_tr_b16 v[222:223], v15 offset:14848
  v_mfma_f32_32x32x16_bf16 v[160:175], v[224:227], v[28:31], v[160:175]
  s_add_u32 m0, s91, 81920
  s_add_u32 s52, s90, 1376384
  buffer_load_dwordx4 v252, s[28:31], s52 offen lds
  v_fmac_f32 v136, v251, v184
  v_fmac_f32 v137, v251, v185
  v_fmac_f32 v138, v251, v186
  v_fmac_f32 v139, v251, v187
  ds_read_b64_tr_b16 v[224:225], v15 offset:16384
  ds_read_b64_tr_b16 v[226:227], v15 offset:16896
  s_waitcnt lgkmcnt(9)
  v_mfma_f32_32x32x16_bf16 v[160:175], v[208:211], v[32:35], v[160:175]
  v_fmac_f32 v140, v251, v188
  v_fmac_f32 v141, v251, v189
  v_fmac_f32 v142, v251, v190
  v_fmac_f32 v143, v251, v191
  ds_read_b64_tr_b16 v[208:209], v15 offset:18432
  ds_read_b64_tr_b16 v[210:211], v15 offset:18944
  s_waitcnt lgkmcnt(8)
  v_mfma_f32_32x32x16_bf16 v[160:175], v[212:215], v[36:39], v[160:175]
  v_fmac_f32 v144, v251, v192
  v_fmac_f32 v145, v251, v193
  v_fmac_f32 v146, v251, v194
  v_fmac_f32 v147, v251, v195
  ds_read_b64_tr_b16 v[212:213], v15 offset:20480
  ds_read_b64_tr_b16 v[214:215], v15 offset:20992
  s_waitcnt lgkmcnt(8)
  v_mfma_f32_32x32x16_bf16 v[160:175], v[216:219], v[40:43], v[160:175]
  v_fmac_f32 v148, v251, v196
  v_fmac_f32 v149, v251, v197
  v_fmac_f32 v150, v251, v198
  v_fmac_f32 v151, v251, v199
  ds_read_b64_tr_b16 v[216:217], v15 offset:22528
  ds_read_b64_tr_b16 v[218:219], v15 offset:23040
  s_waitcnt lgkmcnt(8)
  v_mfma_f32_32x32x16_bf16 v[160:175], v[220:223], v[44:47], v[160:175]
  v_fmac_f32 v152, v251, v200
  v_fmac_f32 v153, v251, v201
  v_fmac_f32 v154, v251, v202
  v_fmac_f32 v155, v251, v203
  ds_read_b64_tr_b16 v[220:221], v15 offset:24576
  ds_read_b64_tr_b16 v[222:223], v15 offset:25088
  s_waitcnt lgkmcnt(8)
  v_mfma_f32_32x32x16_bf16 v[160:175], v[224:227], v[48:51], v[160:175]
  v_fmac_f32 v156, v251, v204
  v_fmac_f32 v157, v251, v205
  v_fmac_f32 v158, v251, v206
  v_fmac_f32 v159, v251, v207
  v_mul_f32 v176, v128, v128
  ds_read_b64_tr_b16 v[224:225], v15 offset:26624
  ds_read_b64_tr_b16 v[226:227], v15 offset:27136
  s_waitcnt lgkmcnt(8)
  v_mfma_f32_32x32x16_bf16 v[160:175], v[208:211], v[52:55], v[160:175]
  v_mul_f32 v177, v129, v129
  v_mul_f32 v178, v130, v130
  v_mul_f32 v179, v131, v131
  v_mul_f32 v180, v132, v132
  v_mul_f32 v181, v133, v133
  v_mul_f32 v182, v134, v134
  ds_read_b64_tr_b16 v[208:209], v15 offset:28672
  ds_read_b64_tr_b16 v[210:211], v15 offset:29184
  s_waitcnt lgkmcnt(8)
  v_mfma_f32_32x32x16_bf16 v[160:175], v[212:215], v[56:59], v[160:175]
  v_mul_f32 v183, v135, v135
  v_mul_f32 v184, v136, v136
  v_mul_f32 v185, v137, v137
  v_mul_f32 v186, v138, v138
  v_mul_f32 v187, v139, v139
  v_mul_f32 v188, v140, v140
  ds_read_b64_tr_b16 v[212:213], v15 offset:30720
  ds_read_b64_tr_b16 v[214:215], v15 offset:31232
  s_waitcnt lgkmcnt(8)
  v_mfma_f32_32x32x16_bf16 v[160:175], v[216:219], v[60:63], v[160:175]
  v_mul_f32 v189, v141, v141
  v_mul_f32 v190, v142, v142
  v_mul_f32 v191, v143, v143
  v_fma_f32 v176, v176, v249, v248
  v_fma_f32 v177, v177, v249, v248
  ds_read_b64_tr_b16 v[216:217], v15 offset:32768
  ds_read_b64_tr_b16 v[218:219], v15 offset:33280
  s_waitcnt lgkmcnt(8)
  v_mfma_f32_32x32x16_bf16 v[160:175], v[220:223], v[64:67], v[160:175]
  v_fma_f32 v178, v178, v249, v248
  v_fma_f32 v179, v179, v249, v248
  v_fma_f32 v180, v180, v249, v248
  v_fma_f32 v181, v181, v249, v248
  ds_read_b64_tr_b16 v[220:221], v15 offset:34816
  ds_read_b64_tr_b16 v[222:223], v15 offset:35328
  s_waitcnt lgkmcnt(8)
  v_mfma_f32_32x32x16_bf16 v[160:175], v[224:227], v[68:71], v[160:175]
  s_waitcnt vmcnt(0)
  s_mov_b64 exec, 1
  ds_add_u32 v243, v12 offset:4
  s_mov_b64 exec, -1
  v_fma_f32 v182, v182, v249, v248
  v_fma_f32 v183, v183, v249, v248
  v_fma_f32 v184, v184, v249, v248
  v_fma_f32 v185, v185, v249, v248
  ds_read_b64_tr_b16 v[224:225], v15 offset:36864
  ds_read_b64_tr_b16 v[226:227], v15 offset:37376
  s_waitcnt lgkmcnt(9)
  v_mfma_f32_32x32x16_bf16 v[160:175], v[208:211], v[72:75], v[160:175]
  ds_read_b32 v11, v243 offset:4
  v_fma_f32 v186, v186, v249, v248
  v_fma_f32 v187, v187, v249, v248
  v_fma_f32 v188, v188, v249, v248
  v_fma_f32 v189, v189, v249, v248
  ds_read_b64_tr_b16 v[208:209], v15 offset:38912
  ds_read_b64_tr_b16 v[210:211], v15 offset:39424
  s_waitcnt lgkmcnt(10)
  v_mfma_f32_32x32x16_bf16 v[160:175], v[212:215], v[76:79], v[160:175]
  s_waitcnt lgkmcnt(2)
  v_readfirstlane_b32 s55, v11
  s_nop 1
  s_cmp_lt_u32 s55, 8
  s_cbranch_scc1 L_cr_24
L_cb_25:
  v_fma_f32 v190, v190, v249, v248
  v_fma_f32 v191, v191, v249, v248
  v_mul_f32 v176, v176, v128
  v_mul_f32 v177, v177, v129
  ds_read_b64_tr_b16 v[212:213], v240 offset:0
  ds_read_b64_tr_b16 v[214:215], v240 offset:512
  v_mfma_f32_32x32x16_bf16 v[160:175], v[216:219], v[80:83], v[160:175]
  ds_read_b32 v11, v243 offset:8
  v_mul_f32 v178, v178, v130
  v_mul_f32 v179, v179, v131
  v_mul_f32 v180, v180, v132
  v_mul_f32 v181, v181, v133
  v_mul_f32 v182, v182, v134
  ds_read_b64_tr_b16 v[216:217], v240 offset:2048
  ds_read_b64_tr_b16 v[218:219], v240 offset:2560
  v_mfma_f32_32x32x16_bf16 v[160:175], v[220:223], v[84:87], v[160:175]
  s_waitcnt lgkmcnt(2)
  v_readfirstlane_b32 s55, v11
  s_nop 1
  s_cmp_lt_u32 s55, 8
  s_cbranch_scc1 L_cr_27
L_cb_28:
  s_add_u32 m0, s5, 40960
  s_add_u32 s52, s12, 0
  buffer_load_dwordx4 v253, s[32:35], s52 offen lds
  v_mul_f32 v183, v183, v135
  v_mul_f32 v184, v184, v136
  v_mul_f32 v185, v185, v137
  v_mul_f32 v186, v186, v138
  ds_read_b64_tr_b16 v[220:221], v240 offset:4096
  ds_read_b64_tr_b16 v[222:223], v240 offset:4608
  v_mfma_f32_32x32x16_bf16 v[160:175], v[224:227], v[88:91], v[160:175]
  v_mul_f32 v187, v187, v139
  v_mul_f32 v188, v188, v140
  v_mul_f32 v189, v189, v141
  v_mul_f32 v190, v190, v142
  v_mul_f32 v191, v191, v143
  v_mul_f32 v144, v144, v128
  ds_read_b64_tr_b16 v[224:225], v240 offset:6144
  ds_read_b64_tr_b16 v[226:227], v240 offset:6656
  v_mfma_f32_32x32x16_bf16 v[160:175], v[208:211], v[92:95], v[160:175]
  s_add_u32 m0, s5, 41984
  s_add_u32 s52, s12, 7168
  buffer_load_dwordx4 v253, s[32:35], s52 offen lds
  v_mul_f32 v145, v145, v129
  v_mul_f32 v146, v146, v130
  v_mul_f32 v147, v147, v131
  v_mul_f32 v148, v148, v132
  v_mul_f32 v149, v149, v133
  ds_read_b64_tr_b16 v[208:209], v240 offset:8192
  ds_read_b64_tr_b16 v[210:211], v240 offset:8704
  v_mfma_f32_32x32x16_bf16 v[160:175], v[212:215], v[96:99], v[160:175]
  v_mul_f32 v150, v150, v134
  v_mul_f32 v151, v151, v135
  v_mul_f32 v152, v152, v136
  v_mul_f32 v153, v153, v137
  v_mul_f32 v154, v154, v138
  v_mul_f32 v155, v155, v139
  ds_read_b64_tr_b16 v[212:213], v240 offset:10240
  ds_read_b64_tr_b16 v[214:215], v240 offset:10752
  s_waitcnt lgkmcnt(8)
  v_mfma_f32_32x32x16_bf16 v[160:175], v[216:219], v[100:103], v[160:175]
  s_add_u32 m0, s6, 90112
  s_add_u32 s52, s13, 0
  buffer_load_dwordx4 v253, s[32:35], s52 offen lds
  v_mul_f32 v156, v156, v140
  v_mul_f32 v157, v157, v141
  v_mul_f32 v158, v158, v142
  v_mul_f32 v159, v159, v143
  ds_read_b64_tr_b16 v[216:217], v240 offset:12288
  ds_read_b64_tr_b16 v[218:219], v240 offset:12800
  s_waitcnt lgkmcnt(8)
  v_mfma_f32_32x32x16_bf16 v[160:175], v[220:223], v[104:107], v[160:175]
  v_exp_f32 v176, v176
  v_exp_f32 v177, v177
  v_exp_f32 v178, v178
  ds_read_b64_tr_b16 v[220:221], v240 offset:14336
  ds_read_b64_tr_b16 v[222:223], v240 offset:14848
  s_waitcnt lgkmcnt(8)
  v_mfma_f32_32x32x16_bf16 v[160:175], v[224:227], v[108:111], v[160:175]
  s_add_u32 m0, s6, 91136
  s_add_u32 s52, s13, 7168
  buffer_load_dwordx4 v253, s[32:35], s52 offen lds
  v_exp_f32 v179, v179
  v_exp_f32 v180, v180
  ds_read_b64_tr_b16 v[224:225], v240 offset:16384
  ds_read_b64_tr_b16 v[226:227], v240 offset:16896
  s_waitcnt lgkmcnt(8)
  v_mfma_f32_32x32x16_bf16 v[160:175], v[208:211], v[112:115], v[160:175]
  v_exp_f32 v181, v181
  v_exp_f32 v182, v182
  v_exp_f32 v183, v183
  ds_read_b64_tr_b16 v[208:209], v240 offset:18432
  ds_read_b64_tr_b16 v[210:211], v240 offset:18944
  s_waitcnt lgkmcnt(8)
  v_mfma_f32_32x32x16_bf16 v[160:175], v[212:215], v[116:119], v[160:175]
  s_add_u32 m0, s6, 92160
  s_add_u32 s52, s14, 0
  buffer_load_dwordx4 v253, s[32:35], s52 offen lds
  v_exp_f32 v184, v184
  v_exp_f32 v185, v185
  ds_read_b64_tr_b16 v[212:213], v240 offset:20480
  ds_read_b64_tr_b16 v[214:215], v240 offset:20992
  s_waitcnt lgkmcnt(8)
  v_mfma_f32_32x32x16_bf16 v[160:175], v[216:219], v[120:123], v[160:175]
  v_exp_f32 v186, v186
  v_exp_f32 v187, v187
  v_exp_f32 v188, v188
  ds_read_b64_tr_b16 v[216:217], v240 offset:22528
  ds_read_b64_tr_b16 v[218:219], v240 offset:23040
  s_waitcnt lgkmcnt(8)
  v_mfma_f32_32x32x16_bf16 v[160:175], v[220:223], v[124:127], v[160:175]
  v_exp_f32 v189, v189
  v_exp_f32 v190, v190
  v_exp_f32 v191, v191
  ds_read_b64_tr_b16 v[220:221], v240 offset:24576
  ds_read_b64_tr_b16 v[222:223], v240 offset:25088
  s_setprio 0
  s_waitcnt lgkmcnt(8)
  v_mfma_f32_32x32x16_bf16 v[128:143], v[224:227], v[16:19], 0
  s_mov_b64 exec, 1
  ds_add_u32 v243, v12 offset:16
  s_mov_b64 exec, -1
  v_fma_f32 v176, v176, v250, v250
  v_fma_f32 v177, v177, v250, v250
  v_fma_f32 v178, v178, v250, v250
  v_fma_f32 v179, v179, v250, v250
  ds_read_b64_tr_b16 v[224:225], v240 offset:26624
  ds_read_b64_tr_b16 v[226:227], v240 offset:27136
  s_waitcnt lgkmcnt(9)
  v_mfma_f32_32x32x16_bf16 v[128:143], v[208:211], v[20:23], v[128:143]
  v_fma_f32 v180, v180, v250, v250
  v_fma_f32 v181, v181, v250, v250
  v_fma_f32 v182, v182, v250, v250
  v_fma_f32 v183, v183, v250, v250
  ds_read_b64_tr_b16 v[208:209], v240 offset:28672
  ds_read_b64_tr_b16 v[210:211], v240 offset:29184
  s_waitcnt lgkmcnt(9)
  v_mfma_f32_32x32x16_bf16 v[128:143], v[212:215], v[24:27], v[128:143]
  ds_read_b32 v11, v243 offset:16
  v_fma_f32 v184, v184, v250, v250
  v_fma_f32 v185, v185, v250, v250
  v_fma_f32 v186, v186, v250, v250
  v_fma_f32 v187, v187, v250, v250
  ds_read_b64_tr_b16 v[212:213], v240 offset:30720
  ds_read_b64_tr_b16 v[214:215], v240 offset:31232
  s_waitcnt lgkmcnt(10)
  v_mfma_f32_32x32x16_bf16 v[128:143], v[216:219], v[28:31], v[128:143]
  s_waitcnt lgkmcnt(2)
  v_readfirstlane_b32 s55, v11
  s_nop 1
  s_cmp_lt_u32 s55, 8
  s_cbranch_scc1 L_cr_30
L_cb_31:
  s_add_u32 m0, s4, 114688
  s_add_u32 s52, s14, 7168
  buffer_load_dwordx4 v253, s[32:35], s52 offen lds
  v_fma_f32 v188, v188, v250, v250
  v_fma_f32 v189, v189, v250, v250
  v_fma_f32 v190, v190, v250, v250
  ds_read_b64_tr_b16 v[216:217], v240 offset:32768
  ds_read_b64_tr_b16 v[218:219], v240 offset:33280
  v_mfma_f32_32x32x16_bf16 v[128:143], v[220:223], v[32:35], v[128:143]
  v_fma_f32 v191, v191, v250, v250
  v_rcp_f32 v176, v176
  v_rcp_f32 v177, v177
  ds_read_b64_tr_b16 v[220:221], v240 offset:34816
  ds_read_b64_tr_b16 v[222:223], v240 offset:35328
  v_mfma_f32_32x32x16_bf16 v[128:143], v[224:227], v[36:39], v[128:143]
  s_add_u32 m0, s4, 115712
  s_add_u32 s52, s15, 0
  buffer_load_dwordx4 v253, s[32:35], s52 offen lds
  v_rcp_f32 v178, v178
  v_rcp_f32 v179, v179
  v_rcp_f32 v180, v180
  ds_read_b64_tr_b16 v[224:225], v240 offset:36864
  ds_read_b64_tr_b16 v[226:227], v240 offset:37376
  v_mfma_f32_32x32x16_bf16 v[128:143], v[208:211], v[40:43], v[128:143]
  v_rcp_f32 v181, v181
  v_rcp_f32 v182, v182
  v_rcp_f32 v183, v183
  ds_read_b64_tr_b16 v[208:209], v240 offset:38912
  ds_read_b64_tr_b16 v[210:211], v240 offset:39424
  s_waitcnt lgkmcnt(8)
  v_mfma_f32_32x32x16_bf16 v[128:143], v[212:215], v[44:47], v[128:143]
  s_add_u32 m0, s4, 116736
  s_add_u32 s52, s15, 7168
  buffer_load_dwordx4 v253, s[32:35], s52 offen lds
  v_rcp_f32 v184, v184
  v_rcp_f32 v185, v185
  v_rcp_f32 v186, v186
  ds_read_b64_tr_b16 v[212:213], v241 offset:0
  ds_read_b64_tr_b16 v[214:215], v241 offset:512
  s_waitcnt lgkmcnt(8)
  v_mfma_f32_32x32x16_bf16 v[128:143], v[216:219], v[48:51], v[128:143]
  v_rcp_f32 v187, v187
  v_rcp_f32 v188, v188
  v_rcp_f32 v189, v189
  ds_read_b64_tr_b16 v[216:217], v241 offset:2048
  ds_read_b64_tr_b16 v[218:219], v241 offset:2560
  s_waitcnt lgkmcnt(8)
  v_mfma_f32_32x32x16_bf16 v[128:143], v[220:223], v[52:55], v[128:143]
  s_add_u32 m0, s4, 117760
  s_add_u32 s52, s16, 0
  buffer_load_dwordx4 v253, s[32:35], s52 offen lds
  v_rcp_f32 v190, v190
  v_rcp_f32 v191, v191
  v_mul_f32 v144, v144, v176
  v_mul_f32 v145, v145, v177
  ds_read_b64_tr_b16 v[220:221], v241 offset:4096
  ds_read_b64_tr_b16 v[222:223], v241 offset:4608
  s_waitcnt lgkmcnt(8)
  v_mfma_f32_32x32x16_bf16 v[128:143], v[224:227], v[56:59], v[128:143]
  v_mul_f32 v146, v146, v178
  v_mul_f32 v147, v147, v179
  v_mul_f32 v148, v148, v180
  v_mul_f32 v149, v149, v181
  v_mul_f32 v150, v150, v182
  v_mul_f32 v151, v151, v183
  ds_read_b64_tr_b16 v[224:225], v241 offset:6144
  ds_read_b64_tr_b16 v[226:227], v241 offset:6656
  s_waitcnt lgkmcnt(8)
  v_mfma_f32_32x32x16_bf16 v[128:143], v[208:211], v[60:63], v[128:143]
  s_add_u32 m0, s4, 118784
  s_add_u32 s52, s16, 7168
  buffer_load_dwordx4 v253, s[32:35], s52 offen lds
  v_mul_f32 v152, v152, v184
  v_mul_f32 v153, v153, v185
  v_mul_f32 v154, v154, v186
  v_mul_f32 v155, v155, v187
  v_mul_f32 v156, v156, v188
  v_mul_f32 v157, v157, v189
  ds_read_b64_tr_b16 v[208:209], v241 offset:8192
  ds_read_b64_tr_b16 v[210:211], v241 offset:8704
  s_waitcnt lgkmcnt(8)
  v_mfma_f32_32x32x16_bf16 v[128:143], v[212:215], v[64:67], v[128:143]
  v_mul_f32 v158, v158, v190
  v_mul_f32 v159, v159, v191
  v_cvt_pk_bf16_f32 v192, v144, v145
  v_cvt_pk_bf16_f32 v193, v146, v147
  v_cvt_pk_bf16_f32 v194, v148, v149
  v_cvt_pk_bf16_f32 v195, v150, v151
  ds_read_b64_tr_b16 v[212:213], v241 offset:10240
  ds_read_b64_tr_b16 v[214:215], v241 offset:10752
  s_waitcnt lgkmcnt(8)
  v_mfma_f32_32x32x16_bf16 v[128:143], v[216:219], v[68:71], v[128:143]
  s_add_u32 m0, s5, 0
  s_add_u32 s52, s17, 0
  buffer_load_dwordx4 v253, s[32:35], s52 offen lds
  v_cvt_pk_bf16_f32 v196, v152, v153
  v_cvt_pk_bf16_f32 v197, v154, v155
  v_cvt_pk_bf16_f32 v198, v156, v157
  v_cvt_pk_bf16_f32 v199, v158, v159
  buffer_store_dwordx4 v[192:195], v4, s[44:47], s75 offen sc1
  buffer_store_dwordx4 v[196:199], v4, s[44:47], s75 offen offset:1024 sc1
  ds_read_b128 v[176:179], v242 offset:256
  ds_read_b128 v[180:183], v242 offset:288
  ds_read_b128 v[184:187], v242 offset:320
  ds_read_b128 v[188:191], v242 offset:352
  ds_read_b64_tr_b16 v[216:217], v241 offset:12288
  ds_read_b64_tr_b16 v[218:219], v241 offset:12800
  s_waitcnt lgkmcnt(12)
  v_mfma_f32_32x32x16_bf16 v[128:143], v[220:223], v[72:75], v[128:143]
  ds_read_b64_tr_b16 v[220:221], v241 offset:14336
  ds_read_b64_tr_b16 v[222:223], v241 offset:14848
  s_waitcnt lgkmcnt(12)
  v_mfma_f32_32x32x16_bf16 v[128:143], v[224:227], v[76:79], v[128:143]
  s_add_u32 m0, s5, 1024
  s_add_u32 s52, s17, 7168
  buffer_load_dwordx4 v253, s[32:35], s52 offen lds
  s_waitcnt lgkmcnt(4)
  v_fmac_f32 v160, v251, v176
  v_fmac_f32 v161, v251, v177
  v_fmac_f32 v162, v251, v178
  v_fmac_f32 v163, v251, v179
  ds_read_b64_tr_b16 v[224:225], v241 offset:16384
  ds_read_b64_tr_b16 v[226:227], v241 offset:16896
  v_mfma_f32_32x32x16_bf16 v[128:143], v[208:211], v[80:83], v[128:143]
  v_fmac_f32 v164, v251, v180
  v_fmac_f32 v165, v251, v181
  v_fmac_f32 v166, v251, v182
  v_fmac_f32 v167, v251, v183
  ds_read_b64_tr_b16 v[208:209], v241 offset:18432
  ds_read_b64_tr_b16 v[210:211], v241 offset:18944
  v_mfma_f32_32x32x16_bf16 v[128:143], v[212:215], v[84:87], v[128:143]
  v_fmac_f32 v168, v251, v184
  v_fmac_f32 v169, v251, v185
  v_fmac_f32 v170, v251, v186
  v_fmac_f32 v171, v251, v187
  ds_read_b64_tr_b16 v[212:213], v241 offset:20480
  ds_read_b64_tr_b16 v[214:215], v241 offset:20992
  s_waitcnt lgkmcnt(8)
  v_mfma_f32_32x32x16_bf16 v[128:143], v[216:219], v[88:91], v[128:143]
  v_fmac_f32 v172, v251, v188
  v_fmac_f32 v173, v251, v189
  v_fmac_f32 v174, v251, v190
  v_fmac_f32 v175, v251, v191
  v_mul_f32 v176, v160, v160
  ds_read_b64_tr_b16 v[216:217], v241 offset:22528
  ds_read_b64_tr_b16 v[218:219], v241 offset:23040
  s_waitcnt lgkmcnt(8)
  v_mfma_f32_32x32x16_bf16 v[128:143], v[220:223], v[92:95], v[128:143]
  v_mul_f32 v177, v161, v161
  v_mul_f32 v178, v162, v162
  v_mul_f32 v179, v163, v163
  v_mul_f32 v180, v164, v164
  v_mul_f32 v181, v165, v165
  v_mul_f32 v182, v166, v166
  ds_read_b64_tr_b16 v[220:221], v241 offset:24576
  ds_read_b64_tr_b16 v[222:223], v241 offset:25088
  s_waitcnt lgkmcnt(8)
  v_mfma_f32_32x32x16_bf16 v[128:143], v[224:227], v[96:99], v[128:143]
  v_mul_f32 v183, v167, v167
  v_mul_f32 v184, v168, v168
  v_mul_f32 v185, v169, v169
  v_mul_f32 v186, v170, v170
  v_mul_f32 v187, v171, v171
  v_mul_f32 v188, v172, v172
  ds_read_b64_tr_b16 v[224:225], v241 offset:26624
  ds_read_b64_tr_b16 v[226:227], v241 offset:27136
  s_waitcnt lgkmcnt(8)
  v_mfma_f32_32x32x16_bf16 v[128:143], v[208:211], v[100:103], v[128:143]
  v_mul_f32 v189, v173, v173
  v_mul_f32 v190, v174, v174
  v_mul_f32 v191, v175, v175
  v_fma_f32 v176, v176, v249, v248
  v_fma_f32 v177, v177, v249, v248
  ds_read_b64_tr_b16 v[208:209], v241 offset:28672
  ds_read_b64_tr_b16 v[210:211], v241 offset:29184
  s_waitcnt lgkmcnt(8)
  v_mfma_f32_32x32x16_bf16 v[128:143], v[212:215], v[104:107], v[128:143]
  ds_read_b128 v[192:195], v242 offset:768
  ds_read_b128 v[196:199], v242 offset:800
  ds_read_b128 v[200:203], v242 offset:832
  ds_read_b128 v[204:207], v242 offset:864
  v_fma_f32 v178, v178, v249, v248
  v_fma_f32 v179, v179, v249, v248
  v_fma_f32 v180, v180, v249, v248
  ds_read_b64_tr_b16 v[212:213], v241 offset:30720
  ds_read_b64_tr_b16 v[214:215], v241 offset:31232
  s_waitcnt lgkmcnt(12)
  v_mfma_f32_32x32x16_bf16 v[128:143], v[216:219], v[108:111], v[128:143]
  v_fma_f32 v181, v181, v249, v248
  v_fma_f32 v182, v182, v249, v248
  v_fma_f32 v183, v183, v249, v248
  v_fma_f32 v184, v184, v249, v248
  s_waitcnt lgkmcnt(10)
  v_mfma_f32_32x32x16_bf16 v[128:143], v[220:223], v[112:115], v[128:143]
  v_fma_f32 v185, v185, v249, v248
  v_fma_f32 v186, v186, v249, v248
  v_fma_f32 v187, v187, v249, v248
  v_fma_f32 v188, v188, v249, v248
  s_waitcnt lgkmcnt(8)
  v_mfma_f32_32x32x16_bf16 v[128:143], v[224:227], v[116:119], v[128:143]
  v_fma_f32 v189, v189, v249, v248
  v_fma_f32 v190, v190, v249, v248
  v_fma_f32 v191, v191, v249, v248
  v_mul_f32 v176, v176, v160
  v_mul_f32 v177, v177, v161
  s_waitcnt lgkmcnt(6)
  v_mfma_f32_32x32x16_bf16 v[128:143], v[208:211], v[120:123], v[128:143]
  v_mul_f32 v178, v178, v162
  v_mul_f32 v179, v179, v163
  v_mul_f32 v180, v180, v164
  v_mul_f32 v181, v181, v165
  v_mul_f32 v182, v182, v166
  v_mul_f32 v183, v183, v167
  s_waitcnt lgkmcnt(0)
  v_mfma_f32_32x32x16_bf16 v[128:143], v[212:215], v[124:127], v[128:143]
  v_mul_f32 v184, v184, v168
  v_mul_f32 v185, v185, v169
  v_mul_f32 v186, v186, v170
  v_mul_f32 v187, v187, v171
  v_mul_f32 v188, v188, v172
  v_mul_f32 v189, v189, v173
  v_mul_f32 v190, v190, v174
  v_mul_f32 v191, v191, v175
  v_exp_f32 v176, v176
  v_exp_f32 v177, v177
  v_exp_f32 v178, v178
  v_exp_f32 v179, v179
  v_exp_f32 v180, v180
  v_exp_f32 v181, v181
  v_exp_f32 v182, v182
  v_exp_f32 v183, v183
  v_exp_f32 v184, v184
  v_exp_f32 v185, v185
  v_exp_f32 v186, v186
  v_exp_f32 v187, v187
  v_exp_f32 v188, v188
  v_exp_f32 v189, v189
  v_exp_f32 v190, v190
  v_exp_f32 v191, v191
  v_fma_f32 v176, v176, v250, v250
  v_fma_f32 v177, v177, v250, v250
  v_fma_f32 v178, v178, v250, v250
  v_fma_f32 v179, v179, v250, v250
  v_fma_f32 v180, v180, v250, v250
  v_fma_f32 v181, v181, v250, v250
  v_fma_f32 v182, v182, v250, v250
  v_fma_f32 v183, v183, v250, v250
  v_fma_f32 v184, v184, v250, v250
  v_fma_f32 v185, v185, v250, v250
  v_fma_f32 v186, v186, v250, v250
  v_fma_f32 v187, v187, v250, v250
  v_fma_f32 v188, v188, v250, v250
  v_fma_f32 v189, v189, v250, v250
  v_fma_f32 v190, v190, v250, v250
  v_fma_f32 v191, v191, v250, v250
  v_rcp_f32 v176, v176
  v_rcp_f32 v177, v177
  v_rcp_f32 v178, v178
  v_rcp_f32 v179, v179
  v_rcp_f32 v180, v180
  v_rcp_f32 v181, v181
  v_rcp_f32 v182, v182
  v_rcp_f32 v183, v183
  v_rcp_f32 v184, v184
  v_rcp_f32 v185, v185
  v_rcp_f32 v186, v186
  v_rcp_f32 v187, v187
  v_rcp_f32 v188, v188
  v_rcp_f32 v189, v189
  v_rcp_f32 v190, v190
  v_rcp_f32 v191, v191
  v_mul_f32 v176, v160, v176
  v_mul_f32 v177, v161, v177
  v_mul_f32 v178, v162, v178
  v_mul_f32 v179, v163, v179
  v_mul_f32 v180, v164, v180
  v_mul_f32 v181, v165, v181
  v_mul_f32 v182, v166, v182
  v_mul_f32 v183, v167, v183
  v_mul_f32 v184, v168, v184
  v_mul_f32 v185, v169, v185
  v_mul_f32 v186, v170, v186
  v_mul_f32 v187, v171, v187
  v_mul_f32 v188, v172, v188
  v_mul_f32 v189, v173, v189
  v_mul_f32 v190, v174, v190
  v_mul_f32 v191, v175, v191
  v_fmac_f32 v128, v251, v192
  v_fmac_f32 v129, v251, v193
  v_fmac_f32 v130, v251, v194
  v_fmac_f32 v131, v251, v195
  v_fmac_f32 v132, v251, v196
  v_fmac_f32 v133, v251, v197
  v_fmac_f32 v134, v251, v198
  v_fmac_f32 v135, v251, v199
  v_fmac_f32 v136, v251, v200
  v_fmac_f32 v137, v251, v201
  v_fmac_f32 v138, v251, v202
  v_fmac_f32 v139, v251, v203
  v_fmac_f32 v140, v251, v204
  v_fmac_f32 v141, v251, v205
  v_fmac_f32 v142, v251, v206
  v_fmac_f32 v143, v251, v207
  v_mul_f32 v128, v128, v176
  v_mul_f32 v129, v129, v177
  v_mul_f32 v130, v130, v178
  v_mul_f32 v131, v131, v179
  v_mul_f32 v132, v132, v180
  v_mul_f32 v133, v133, v181
  v_mul_f32 v134, v134, v182
  v_mul_f32 v135, v135, v183
  v_mul_f32 v136, v136, v184
  v_mul_f32 v137, v137, v185
  v_mul_f32 v138, v138, v186
  v_mul_f32 v139, v139, v187
  v_mul_f32 v140, v140, v188
  v_mul_f32 v141, v141, v189
  v_mul_f32 v142, v142, v190
  v_mul_f32 v143, v143, v191
  v_cvt_pk_bf16_f32 v192, v128, v129
  v_cvt_pk_bf16_f32 v193, v130, v131
  v_cvt_pk_bf16_f32 v194, v132, v133
  v_cvt_pk_bf16_f32 v195, v134, v135
  v_cvt_pk_bf16_f32 v196, v136, v137
  v_cvt_pk_bf16_f32 v197, v138, v139
  v_cvt_pk_bf16_f32 v198, v140, v141
  v_cvt_pk_bf16_f32 v199, v142, v143
  s_add_u32 s63, s75, 4096
  buffer_store_dwordx4 v[192:195], v4, s[44:47], s63 offen sc1
  buffer_store_dwordx4 v[196:199], v4, s[44:47], s63 offen offset:1024 sc1
  v_bfe_u32 v5, v1, 2, 2
  v_lshl_add_u32 v6, v254, 2, v5
  v_lshlrev_b32 v6, 7, v6
  v_lshrrev_b32 v5, 1, v5
  v_lshl_add_u32 v6, v5, 6, v6
  v_and_b32 v5, 1, v2
  v_lshl_add_u32 v6, v5, 5, v6
  v_and_b32 v5, 3, v1
  v_lshl_add_u32 v11, v5, 3, v6
  v_add_u32 v5, s4, v11
  v_add_u32 v5, 114688, v5
  v_xor_b32 v6, 64, v5
  v_add_u32 v7, s5, v11
  v_xor_b32 v8, 64, v7
  v_add_u32 v9, s6, v11
  v_add_u32 v9, 16384, v9
  v_xor_b32 v10, 64, v9
  v_add_u32 v2, s6, v11
  v_add_u32 v2, 90112, v2
  v_xor_b32 v3, 64, v2
  v_add_u32 v252, s83, v11
  v_add_u32 v252, 57344, v252
  v_xor_b32 v15, 64, v252
  s_setprio 3
  s_waitcnt vmcnt(2)
  ds_read_b64_tr_b16 v[16:17], v7 offset:40960
  ds_read_b64_tr_b16 v[20:21], v8 offset:40960
  ds_read_b64_tr_b16 v[18:19], v7 offset:41984
  ds_read_b64_tr_b16 v[22:23], v8 offset:41984
  ds_read_b64_tr_b16 v[24:25], v2 offset:0
  ds_read_b64_tr_b16 v[28:29], v3 offset:0
  ds_read_b64_tr_b16 v[26:27], v2 offset:1024
  ds_read_b64_tr_b16 v[30:31], v3 offset:1024
  ds_read_b64_tr_b16 v[32:33], v2 offset:2048
  ds_read_b64_tr_b16 v[36:37], v3 offset:2048
  ds_read_b64_tr_b16 v[34:35], v5 offset:0
  ds_read_b64_tr_b16 v[38:39], v6 offset:0
  ds_read_b64_tr_b16 v[40:41], v5 offset:1024
  ds_read_b64_tr_b16 v[44:45], v6 offset:1024
  ds_read_b64_tr_b16 v[42:43], v5 offset:2048
  ds_read_b64_tr_b16 v[46:47], v6 offset:2048
  ds_read_b64_tr_b16 v[48:49], v5 offset:3072
  ds_read_b64_tr_b16 v[52:53], v6 offset:3072
  ds_read_b64_tr_b16 v[50:51], v5 offset:4096
  ds_read_b64_tr_b16 v[54:55], v6 offset:4096
  ds_read_b64_tr_b16 v[56:57], v7 offset:0
  ds_read_b64_tr_b16 v[60:61], v8 offset:0
  ds_read_b64_tr_b16 v[58:59], v7 offset:1024
  ds_read_b64_tr_b16 v[62:63], v8 offset:1024
  s_waitcnt lgkmcnt(0)
  s_add_u32 m0, s5, 40960
  s_add_u32 s52, s14, 64512
  buffer_load_dwordx4 v253, s[32:35], s52 offen lds
  s_add_u32 m0, s5, 41984
  s_add_u32 s52, s15, 57344
  buffer_load_dwordx4 v253, s[32:35], s52 offen lds
  s_add_u32 m0, s6, 90112
  s_add_u32 s52, s15, 64512
  buffer_load_dwordx4 v253, s[32:35], s52 offen lds
  s_add_u32 m0, s6, 91136
  s_add_u32 s52, s16, 57344
  buffer_load_dwordx4 v253, s[32:35], s52 offen lds
  s_waitcnt vmcnt(4)
  s_mov_b64 exec, 1
  ds_add_rtn_u32 v14, v243, v12 offset:24
  s_mov_b64 exec, -1
  s_waitcnt lgkmcnt(0)
  v_readfirstlane_b32 s55, v14
  s_nop 1
  s_cmp_lg_u32 s55, 7
  s_cbranch_scc1 L_hs_61
  s_mov_b64 exec, 1
  s_lshl_b32 s51, s48, 8
  s_add_u32 s51, s51, 12288
  v_mov_b32 v13, s51
  buffer_atomic_add v12, v13, s[44:47], 0 offen sc1
  s_mov_b64 exec, -1
L_hs_61:
  s_add_u32 m0, s6, 92160
  s_add_u32 s52, s16, 64512
  buffer_load_dwordx4 v253, s[32:35], s52 offen lds
  s_add_u32 m0, s4, 114688
  s_add_u32 s52, s17, 57344
  buffer_load_dwordx4 v253, s[32:35], s52 offen lds
  s_add_u32 m0, s4, 115712
  s_add_u32 s52, s17, 64512
  buffer_load_dwordx4 v253, s[32:35], s52 offen lds
  s_add_u32 m0, s4, 116736
  s_add_u32 s52, s18, 57344
  buffer_load_dwordx4 v253, s[32:35], s52 offen lds
  s_add_u32 m0, s4, 117760
  s_add_u32 s52, s18, 64512
  buffer_load_dwordx4 v253, s[32:35], s52 offen lds
  s_barrier
  s_add_u32 m0, s6, 16384
  s_add_u32 s52, s18, 0
  buffer_load_dwordx4 v253, s[32:35], s52 offen lds
  s_add_u32 m0, s6, 17408
  s_add_u32 s52, s18, 7168
  buffer_load_dwordx4 v253, s[32:35], s52 offen lds
  s_add_u32 m0, s6, 18432
  s_add_u32 s52, s12, 57344
  buffer_load_dwordx4 v253, s[32:35], s52 offen lds
  s_add_u32 m0, s83, 57344
  s_add_u32 s52, s12, 64512
  buffer_load_dwordx4 v253, s[32:35], s52 offen lds
  s_add_u32 m0, s83, 58368
  s_add_u32 s52, s13, 57344
  buffer_load_dwordx4 v253, s[32:35], s52 offen lds
  s_add_u32 m0, s83, 59392
  s_add_u32 s52, s13, 64512
  buffer_load_dwordx4 v253, s[32:35], s52 offen lds
  s_add_u32 m0, s83, 60416
  s_add_u32 s52, s14, 57344
  buffer_load_dwordx4 v253, s[32:35], s52 offen lds
  s_setprio 0
  s_cmp_lg_u32 s50, 0
  s_cbranch_scc1 L_fp_62
  s_mov_b64 exec, 1
  s_lshl_b32 s51, s93, 8
  s_add_u32 s51, s51, 12288
  s_add_u32 s51, s51, 0
  v_mov_b32 v13, s51
  s_mov_b32 s56, 0
L_poll_63:
  buffer_load_dword v11, v13, s[44:47], 0 offen sc1
  s_waitcnt vmcnt(0)
  v_readfirstlane_b32 s55, v11
  s_add_u32 s56, s56, 1
  s_cmp_ge_u32 s56, 200000
  s_cbranch_scc1 L_pdone_64
  s_cmp_lt_u32 s55, 14
  s_cbranch_scc1 L_poll_63
L_pdone_64:
  s_mov_b64 exec, -1
L_fp_62:
  s_waitcnt vmcnt(7)
  ds_read_b64_tr_b16 v[90:91], v7 offset:40960
  ds_read_b64_tr_b16 v[94:95], v8 offset:40960
  ds_read_b64_tr_b16 v[96:97], v7 offset:41984
  ds_read_b64_tr_b16 v[100:101], v8 offset:41984
  ds_read_b64_tr_b16 v[98:99], v2 offset:0
  ds_read_b64_tr_b16 v[102:103], v3 offset:0
  ds_read_b64_tr_b16 v[104:105], v2 offset:1024
  ds_read_b64_tr_b16 v[108:109], v3 offset:1024
  ds_read_b64_tr_b16 v[106:107], v2 offset:2048
  ds_read_b64_tr_b16 v[110:111], v3 offset:2048
  ds_read_b64_tr_b16 v[112:113], v5 offset:0
  ds_read_b64_tr_b16 v[116:117], v6 offset:0
  ds_read_b64_tr_b16 v[114:115], v5 offset:1024
  ds_read_b64_tr_b16 v[118:119], v6 offset:1024
  ds_read_b64_tr_b16 v[120:121], v5 offset:2048
  ds_read_b64_tr_b16 v[124:125], v6 offset:2048
  ds_read_b64_tr_b16 v[122:123], v5 offset:3072
  ds_read_b64_tr_b16 v[126:127], v6 offset:3072
  s_waitcnt vmcnt(0)
  ds_read_b64_tr_b16 v[64:65], v9 offset:0
  ds_read_b64_tr_b16 v[68:69], v10 offset:0
  ds_read_b64_tr_b16 v[66:67], v9 offset:1024
  ds_read_b64_tr_b16 v[70:71], v10 offset:1024
  ds_read_b64_tr_b16 v[72:73], v9 offset:2048
  ds_read_b64_tr_b16 v[76:77], v10 offset:2048
  ds_read_b64_tr_b16 v[74:75], v252 offset:0
  ds_read_b64_tr_b16 v[78:79], v15 offset:0
  ds_read_b64_tr_b16 v[80:81], v252 offset:1024
  ds_read_b64_tr_b16 v[84:85], v15 offset:1024
  ds_read_b64_tr_b16 v[82:83], v252 offset:2048
  ds_read_b64_tr_b16 v[86:87], v15 offset:2048
  ds_read_b64_tr_b16 v[88:89], v252 offset:3072
  ds_read_b64_tr_b16 v[92:93], v15 offset:3072
  s_waitcnt lgkmcnt(0)
  s_barrier
  s_add_u32 s52, s19, 0
  buffer_load_dwordx4 v[128:131], v4, s[44:47], s52 offen sc1
  s_add_u32 s52, s20, 0
  buffer_load_dwordx4 v[132:135], v4, s[44:47], s52 offen sc1
  s_add_u32 s52, s21, 0
  buffer_load_dwordx4 v[136:139], v4, s[44:47], s52 offen sc1
  s_add_u32 s52, s22, 0
  buffer_load_dwordx4 v[140:143], v4, s[44:47], s52 offen sc1
  s_add_u32 s52, s23, 0
  buffer_load_dwordx4 v[144:147], v4, s[44:47], s52 offen sc1
  s_add_u32 s52, s81, 0
  buffer_load_dwordx4 v[148:151], v4, s[44:47], s52 offen sc1
  s_add_u32 s52, s82, 0
  buffer_load_dwordx4 v[152:155], v4, s[44:47], s52 offen sc1
  s_add_u32 s52, s19, 4096
  buffer_load_dwordx4 v[156:159], v4, s[44:47], s52 offen sc1
  s_add_u32 s52, s20, 4096
  buffer_load_dwordx4 v[160:163], v4, s[44:47], s52 offen sc1
  s_add_u32 s52, s21, 4096
  buffer_load_dwordx4 v[164:167], v4, s[44:47], s52 offen sc1
  s_add_u32 s52, s22, 4096
  buffer_load_dwordx4 v[168:171], v4, s[44:47], s52 offen sc1
  s_add_u32 s52, s23, 4096
  buffer_load_dwordx4 v[172:175], v4, s[44:47], s52 offen sc1
  s_add_u32 s52, s81, 4096
  buffer_load_dwordx4 v[176:179], v4, s[44:47], s52 offen sc1
  s_add_u32 s52, s82, 4096
  buffer_load_dwordx4 v[180:183], v4, s[44:47], s52 offen sc1
  v_and_b32 v5, 15, v0
  v_lshrrev_b32 v6, 4, v0
  v_lshrrev_b32 v11, 1, v5
  v_lshlrev_b32 v11, 9, v11
  v_lshl_add_u32 v11, v6, 4, v11
  v_and_b32 v7, 1, v5
  v_lshl_add_u32 v11, v7, 3, v11
  s_mul_i32 s63, s61, 28672
  s_lshl_b32 s52, s65, 12
  s_add_u32 s63, s63, s52
  s_add_u32 s63, s63, 4194304
  s_add_u32 s62, s63, 28672
  s_mul_i32 s51, s50, 17408
  v_mul_u32_u24 v8, 272, v255
  v_lshl_add_u32 v8, v254, 4, v8
  v_add_u32 v8, s51, v8
  v_mul_u32_u24 v9, 272, v6
  v_lshl_add_u32 v9, v5, 4, v9
  v_add_u32 v10, 69632, v9
  v_mul_u32_u24 v7, 896, v6
  v_lshl_add_u32 v7, v5, 3, v7
  s_mul_i32 s51, s61, 28672
  s_lshl_b32 s53, s65, 7
  s_add_u32 s51, s51, s53
  s_add_u32 s53, s51, 28672
  s_waitcnt vmcnt(13)
  v_mfma_f32_32x32x16_bf16 v[184:199], v[16:19], v[128:131], 0
  v_mfma_f32_32x32x16_bf16 v[200:215], v[20:23], v[128:131], 0
  s_add_u32 s52, s19, 114688
  buffer_load_dwordx4 v[128:131], v4, s[44:47], s52 offen sc1
  s_waitcnt vmcnt(13)
  v_mfma_f32_32x32x16_bf16 v[184:199], v[24:27], v[132:135], v[184:199]
  v_mfma_f32_32x32x16_bf16 v[200:215], v[28:31], v[132:135], v[200:215]
  s_add_u32 s52, s20, 114688
  buffer_load_dwordx4 v[132:135], v4, s[44:47], s52 offen sc1
  s_waitcnt vmcnt(13)
  v_mfma_f32_32x32x16_bf16 v[184:199], v[32:35], v[136:139], v[184:199]
  v_mfma_f32_32x32x16_bf16 v[200:215], v[36:39], v[136:139], v[200:215]
  s_add_u32 s52, s21, 114688
  buffer_load_dwordx4 v[136:139], v4, s[44:47], s52 offen sc1
  s_waitcnt vmcnt(13)
  v_mfma_f32_32x32x16_bf16 v[184:199], v[40:43], v[140:143], v[184:199]
  v_mfma_f32_32x32x16_bf16 v[200:215], v[44:47], v[140:143], v[200:215]
  s_add_u32 s52, s22, 114688
  buffer_load_dwordx4 v[140:143], v4, s[44:47], s52 offen sc1
  s_waitcnt vmcnt(13)
  v_mfma_f32_32x32x16_bf16 v[184:199], v[48:51], v[144:147], v[184:199]
  v_mfma_f32_32x32x16_bf16 v[200:215], v[52:55], v[144:147], v[200:215]
  s_add_u32 s52, s23, 114688
  buffer_load_dwordx4 v[144:147], v4, s[44:47], s52 offen sc1
  s_waitcnt vmcnt(13)
  v_mfma_f32_32x32x16_bf16 v[184:199], v[56:59], v[148:151], v[184:199]
  v_mfma_f32_32x32x16_bf16 v[200:215], v[60:63], v[148:151], v[200:215]
  s_add_u32 s52, s81, 114688
  buffer_load_dwordx4 v[148:151], v4, s[44:47], s52 offen sc1
  s_waitcnt vmcnt(13)
  v_mfma_f32_32x32x16_bf16 v[184:199], v[64:67], v[152:155], v[184:199]
  v_mfma_f32_32x32x16_bf16 v[200:215], v[68:71], v[152:155], v[200:215]
  s_add_u32 s52, s82, 114688
  buffer_load_dwordx4 v[152:155], v4, s[44:47], s52 offen sc1
  s_waitcnt vmcnt(13)
  v_mfma_f32_32x32x16_bf16 v[184:199], v[72:75], v[156:159], v[184:199]
  v_mfma_f32_32x32x16_bf16 v[200:215], v[76:79], v[156:159], v[200:215]
  s_add_u32 s52, s19, 118784
  buffer_load_dwordx4 v[156:159], v4, s[44:47], s52 offen sc1
  s_waitcnt vmcnt(13)
  v_mfma_f32_32x32x16_bf16 v[184:199], v[80:83], v[160:163], v[184:199]
  v_mfma_f32_32x32x16_bf16 v[200:215], v[84:87], v[160:163], v[200:215]
  s_add_u32 s52, s20, 118784
  buffer_load_dwordx4 v[160:163], v4, s[44:47], s52 offen sc1
  s_waitcnt vmcnt(13)
  v_mfma_f32_32x32x16_bf16 v[184:199], v[88:91], v[164:167], v[184:199]
  v_mfma_f32_32x32x16_bf16 v[200:215], v[92:95], v[164:167], v[200:215]
  s_add_u32 s52, s21, 118784
  buffer_load_dwordx4 v[164:167], v4, s[44:47], s52 offen sc1
  s_waitcnt vmcnt(13)
  v_mfma_f32_32x32x16_bf16 v[184:199], v[96:99], v[168:171], v[184:199]
  v_mfma_f32_32x32x16_bf16 v[200:215], v[100:103], v[168:171], v[200:215]
  s_add_u32 s52, s22, 118784
  buffer_load_dwordx4 v[168:171], v4, s[44:47], s52 offen sc1
  s_waitcnt vmcnt(13)
  v_mfma_f32_32x32x16_bf16 v[184:199], v[104:107], v[172:175], v[184:199]
  v_mfma_f32_32x32x16_bf16 v[200:215], v[108:111], v[172:175], v[200:215]
  s_add_u32 s52, s23, 118784
  buffer_load_dwordx4 v[172:175], v4, s[44:47], s52 offen sc1
  s_waitcnt vmcnt(13)
  v_mfma_f32_32x32x16_bf16 v[184:199], v[112:115], v[176:179], v[184:199]
  v_mfma_f32_32x32x16_bf16 v[200:215], v[116:119], v[176:179], v[200:215]
  s_add_u32 s52, s81, 118784
  buffer_load_dwordx4 v[176:179], v4, s[44:47], s52 offen sc1
  s_waitcnt vmcnt(13)
  v_mfma_f32_32x32x16_bf16 v[184:199], v[120:123], v[180:183], v[184:199]
  v_mfma_f32_32x32x16_bf16 v[200:215], v[124:127], v[180:183], v[200:215]
  s_add_u32 s52, s82, 118784
  buffer_load_dwordx4 v[180:183], v4, s[44:47], s52 offen sc1
  buffer_load_dwordx2 v[248:249], v11, s[44:47], s63 offen sc1
  buffer_load_dwordx2 v[250:251], v11, s[44:47], s62 offen sc1
  s_waitcnt vmcnt(15)
  v_mfma_f32_32x32x16_bf16 v[216:231], v[16:19], v[128:131], 0
  v_mfma_f32_32x32x16_bf16 v[232:247], v[20:23], v[128:131], 0
  s_waitcnt vmcnt(14)
  v_mfma_f32_32x32x16_bf16 v[216:231], v[24:27], v[132:135], v[216:231]
  v_mfma_f32_32x32x16_bf16 v[232:247], v[28:31], v[132:135], v[232:247]
  s_waitcnt vmcnt(13)
  v_mfma_f32_32x32x16_bf16 v[216:231], v[32:35], v[136:139], v[216:231]
  v_mfma_f32_32x32x16_bf16 v[232:247], v[36:39], v[136:139], v[232:247]
  ds_write_b128 v8, v[184:187] offset:0
  s_waitcnt vmcnt(12)
  v_mfma_f32_32x32x16_bf16 v[216:231], v[40:43], v[140:143], v[216:231]
  v_mfma_f32_32x32x16_bf16 v[232:247], v[44:47], v[140:143], v[232:247]
  ds_write_b128 v8, v[188:191] offset:32
  s_waitcnt vmcnt(11)
  v_mfma_f32_32x32x16_bf16 v[216:231], v[48:51], v[144:147], v[216:231]
  v_mfma_f32_32x32x16_bf16 v[232:247], v[52:55], v[144:147], v[232:247]
  ds_write_b128 v8, v[192:195] offset:64
  s_waitcnt vmcnt(10)
  v_mfma_f32_32x32x16_bf16 v[216:231], v[56:59], v[148:151], v[216:231]
  v_mfma_f32_32x32x16_bf16 v[232:247], v[60:63], v[148:151], v[232:247]
  ds_write_b128 v8, v[196:199] offset:96
  s_waitcnt vmcnt(9)
  v_mfma_f32_32x32x16_bf16 v[216:231], v[64:67], v[152:155], v[216:231]
  v_mfma_f32_32x32x16_bf16 v[232:247], v[68:71], v[152:155], v[232:247]
  ds_write_b128 v8, v[200:203] offset:128
  s_waitcnt vmcnt(8)
  v_mfma_f32_32x32x16_bf16 v[216:231], v[72:75], v[156:159], v[216:231]
  v_mfma_f32_32x32x16_bf16 v[232:247], v[76:79], v[156:159], v[232:247]
  ds_write_b128 v8, v[204:207] offset:160
  s_waitcnt vmcnt(7)
  v_mfma_f32_32x32x16_bf16 v[216:231], v[80:83], v[160:163], v[216:231]
  v_mfma_f32_32x32x16_bf16 v[232:247], v[84:87], v[160:163], v[232:247]
  ds_write_b128 v8, v[208:211] offset:192
  s_waitcnt vmcnt(6)
  v_mfma_f32_32x32x16_bf16 v[216:231], v[88:91], v[164:167], v[216:231]
  v_mfma_f32_32x32x16_bf16 v[232:247], v[92:95], v[164:167], v[232:247]
  ds_write_b128 v8, v[212:215] offset:224
  s_waitcnt vmcnt(5)
  v_mfma_f32_32x32x16_bf16 v[216:231], v[96:99], v[168:171], v[216:231]
  v_mfma_f32_32x32x16_bf16 v[232:247], v[100:103], v[168:171], v[232:247]
  s_waitcnt vmcnt(4)
  v_mfma_f32_32x32x16_bf16 v[216:231], v[104:107], v[172:175], v[216:231]
  v_mfma_f32_32x32x16_bf16 v[232:247], v[108:111], v[172:175], v[232:247]
  s_waitcnt vmcnt(3)
  v_mfma_f32_32x32x16_bf16 v[216:231], v[112:115], v[176:179], v[216:231]
  v_mfma_f32_32x32x16_bf16 v[232:247], v[116:119], v[176:179], v[232:247]
  s_waitcnt vmcnt(2)
  v_mfma_f32_32x32x16_bf16 v[216:231], v[120:123], v[180:183], v[216:231]
  v_mfma_f32_32x32x16_bf16 v[232:247], v[124:127], v[180:183], v[232:247]
  s_nop 10
  ds_write_b128 v8, v[216:219] offset:8704
  ds_write_b128 v8, v[220:223] offset:8736
  ds_write_b128 v8, v[224:227] offset:8768
  ds_write_b128 v8, v[228:231] offset:8800
  ds_write_b128 v8, v[232:235] offset:8832
  ds_write_b128 v8, v[236:239] offset:8864
  ds_write_b128 v8, v[240:243] offset:8896
  ds_write_b128 v8, v[244:247] offset:8928
  s_waitcnt lgkmcnt(0)
  s_barrier
  ds_read_b128 v[16:19], v9 offset:0
  ds_read_b128 v[20:23], v9 offset:17408
  ds_read_b128 v[24:27], v9 offset:34816
  ds_read_b128 v[28:31], v9 offset:52224
  ds_read_b128 v[32:35], v10 offset:0
  ds_read_b128 v[36:39], v10 offset:17408
  ds_read_b128 v[40:43], v10 offset:34816
  ds_read_b128 v[44:47], v10 offset:52224
  ds_read_b128 v[56:59], v9 offset:8704
  ds_read_b128 v[60:63], v9 offset:26112
  ds_read_b128 v[64:67], v9 offset:43520
  ds_read_b128 v[68:71], v9 offset:60928
  ds_read_b128 v[72:75], v10 offset:8704
  ds_read_b128 v[76:79], v10 offset:26112
  ds_read_b128 v[80:83], v10 offset:43520
  ds_read_b128 v[84:87], v10 offset:60928
  s_waitcnt vmcnt(0)
  v_lshlrev_b32 v48, 16, v248
  v_and_b32 v49, 0xffff0000, v248
  v_lshlrev_b32 v50, 16, v249
  v_and_b32 v51, 0xffff0000, v249
  s_waitcnt lgkmcnt(8)
  v_add_f32 v16, v16, v32
  v_add_f32 v17, v17, v33
  v_add_f32 v18, v18, v34
  v_add_f32 v19, v19, v35
  v_add_f32 v20, v20, v36
  v_add_f32 v21, v21, v37
  v_add_f32 v22, v22, v38
  v_add_f32 v23, v23, v39
  v_add_f32 v24, v24, v40
  v_add_f32 v25, v25, v41
  v_add_f32 v26, v26, v42
  v_add_f32 v27, v27, v43
  v_add_f32 v28, v28, v44
  v_add_f32 v29, v29, v45
  v_add_f32 v30, v30, v46
  v_add_f32 v31, v31, v47
  v_add_f32 v16, v16, v24
  v_add_f32 v17, v17, v25
  v_add_f32 v18, v18, v26
  v_add_f32 v19, v19, v27
  v_add_f32 v20, v20, v28
  v_add_f32 v21, v21, v29
  v_add_f32 v22, v22, v30
  v_add_f32 v23, v23, v31
  v_add_f32 v16, v16, v20
  v_add_f32 v17, v17, v21
  v_add_f32 v18, v18, v22
  v_add_f32 v19, v19, v23
  v_add_f32 v16, v16, v48
  v_add_f32 v17, v17, v49
  v_add_f32 v18, v18, v50
  v_add_f32 v19, v19, v51
  v_cvt_pk_bf16_f32 v20, v16, v17
  v_cvt_pk_bf16_f32 v21, v18, v19
  buffer_store_dwordx2 v[20:21], v7, s[36:39], s51 offen
  v_lshlrev_b32 v88, 16, v250
  v_and_b32 v89, 0xffff0000, v250
  v_lshlrev_b32 v90, 16, v251
  v_and_b32 v91, 0xffff0000, v251
  s_waitcnt lgkmcnt(0)
  v_add_f32 v56, v56, v72
  v_add_f32 v57, v57, v73
  v_add_f32 v58, v58, v74
  v_add_f32 v59, v59, v75
  v_add_f32 v60, v60, v76
  v_add_f32 v61, v61, v77
  v_add_f32 v62, v62, v78
  v_add_f32 v63, v63, v79
  v_add_f32 v64, v64, v80
  v_add_f32 v65, v65, v81
  v_add_f32 v66, v66, v82
  v_add_f32 v67, v67, v83
  v_add_f32 v68, v68, v84
  v_add_f32 v69, v69, v85
  v_add_f32 v70, v70, v86
  v_add_f32 v71, v71, v87
  v_add_f32 v56, v56, v64
  v_add_f32 v57, v57, v65
  v_add_f32 v58, v58, v66
  v_add_f32 v59, v59, v67
  v_add_f32 v60, v60, v68
  v_add_f32 v61, v61, v69
  v_add_f32 v62, v62, v70
  v_add_f32 v63, v63, v71
  v_add_f32 v56, v56, v60
  v_add_f32 v57, v57, v61
  v_add_f32 v58, v58, v62
  v_add_f32 v59, v59, v63
  v_add_f32 v56, v56, v88
  v_add_f32 v57, v57, v89
  v_add_f32 v58, v58, v90
  v_add_f32 v59, v59, v91
  v_cvt_pk_bf16_f32 v60, v56, v57
  v_cvt_pk_bf16_f32 v61, v58, v59
  buffer_store_dwordx2 v[60:61], v7, s[36:39], s53 offen
L_end:
  s_endpgm
L_ir_3:
  v_lshlrev_b32 v13, 4, v3
  s_mov_b32 s56, 0
L_ic_5:
  s_sleep 8
  buffer_load_dword v14, v13, s[40:43], 0 offen sc1
  s_waitcnt vmcnt(0)
  v_cmp_gt_u32 vcc, 16, v14
  s_add_u32 s56, s56, 1
  s_cmp_ge_u32 s56, 200000
  s_cbranch_scc1 L_icd_6
  s_cmp_lg_u64 vcc, 0
  s_cbranch_scc1 L_ic_5
L_icd_6:
  s_branch L_ib_4
L_sr_7:
  s_mov_b32 s56, 0
L_dp_9:
  s_mov_b32 s51, s88
  buffer_load_dwordx4 v[40:43], v4, s[44:47], s51 offen sc1
  s_add_u32 s51, s51, 4096
  buffer_load_dwordx4 v[44:47], v4, s[44:47], s51 offen sc1
  s_add_u32 s51, s51, 4096
  buffer_load_dwordx4 v[48:51], v4, s[44:47], s51 offen sc1
  s_add_u32 s51, s51, 4096
  buffer_load_dwordx4 v[52:55], v4, s[44:47], s51 offen sc1
  s_add_u32 s51, s51, 4096
  buffer_load_dwordx4 v[56:59], v4, s[44:47], s51 offen sc1
  s_add_u32 s51, s51, 4096
  buffer_load_dwordx4 v[60:63], v4, s[44:47], s51 offen sc1
  s_add_u32 s51, s51, 4096
  buffer_load_dwordx4 v[64:67], v4, s[44:47], s51 offen sc1
  s_add_u32 s51, s51, 4096
  buffer_load_dwordx4 v[68:71], v4, s[44:47], s51 offen sc1
  v_mov_b32 v96, 0
  v_mov_b32 v97, 0
  v_mov_b32 v98, 0
  v_mov_b32 v99, 0
  v_mov_b32 v100, 0
  v_mov_b32 v101, 0
  v_mov_b32 v102, 0
  v_mov_b32 v103, 0
  s_waitcnt vmcnt(7)
  v_dot2_f32_bf16 v96, v40, v8, v96
  v_dot2_f32_bf16 v97, v40, v9, v97
  v_dot2_f32_bf16 v98, v41, v8, v98
  v_dot2_f32_bf16 v99, v41, v9, v99
  v_dot2_f32_bf16 v100, v42, v8, v100
  v_dot2_f32_bf16 v101, v42, v9, v101
  v_dot2_f32_bf16 v102, v43, v8, v102
  v_dot2_f32_bf16 v103, v43, v9, v103
  s_waitcnt vmcnt(6)
  v_dot2_f32_bf16 v96, v44, v8, v96
  v_dot2_f32_bf16 v97, v44, v9, v97
  v_dot2_f32_bf16 v98, v45, v8, v98
  v_dot2_f32_bf16 v99, v45, v9, v99
  v_dot2_f32_bf16 v100, v46, v8, v100
  v_dot2_f32_bf16 v101, v46, v9, v101
  v_dot2_f32_bf16 v102, v47, v8, v102
  v_dot2_f32_bf16 v103, v47, v9, v103
  s_waitcnt vmcnt(5)
  v_dot2_f32_bf16 v96, v48, v8, v96
  v_dot2_f32_bf16 v97, v48, v9, v97
  v_dot2_f32_bf16 v98, v49, v8, v98
  v_dot2_f32_bf16 v99, v49, v9, v99
  v_dot2_f32_bf16 v100, v50, v8, v100
  v_dot2_f32_bf16 v101, v50, v9, v101
  v_dot2_f32_bf16 v102, v51, v8, v102
  v_dot2_f32_bf16 v103, v51, v9, v103
  s_waitcnt vmcnt(4)
  v_dot2_f32_bf16 v96, v52, v8, v96
  v_dot2_f32_bf16 v97, v52, v9, v97
  v_dot2_f32_bf16 v98, v53, v8, v98
  v_dot2_f32_bf16 v99, v53, v9, v99
  v_dot2_f32_bf16 v100, v54, v8, v100
  v_dot2_f32_bf16 v101, v54, v9, v101
  v_dot2_f32_bf16 v102, v55, v8, v102
  v_dot2_f32_bf16 v103, v55, v9, v103
  s_waitcnt vmcnt(3)
  v_dot2_f32_bf16 v96, v56, v8, v96
  v_dot2_f32_bf16 v97, v56, v9, v97
  v_dot2_f32_bf16 v98, v57, v8, v98
  v_dot2_f32_bf16 v99, v57, v9, v99
  v_dot2_f32_bf16 v100, v58, v8, v100
  v_dot2_f32_bf16 v101, v58, v9, v101
  v_dot2_f32_bf16 v102, v59, v8, v102
  v_dot2_f32_bf16 v103, v59, v9, v103
  s_waitcnt vmcnt(2)
  v_dot2_f32_bf16 v96, v60, v8, v96
  v_dot2_f32_bf16 v97, v60, v9, v97
  v_dot2_f32_bf16 v98, v61, v8, v98
  v_dot2_f32_bf16 v99, v61, v9, v99
  v_dot2_f32_bf16 v100, v62, v8, v100
  v_dot2_f32_bf16 v101, v62, v9, v101
  v_dot2_f32_bf16 v102, v63, v8, v102
  v_dot2_f32_bf16 v103, v63, v9, v103
  s_waitcnt vmcnt(1)
  v_dot2_f32_bf16 v96, v64, v8, v96
  v_dot2_f32_bf16 v97, v64, v9, v97
  v_dot2_f32_bf16 v98, v65, v8, v98
  v_dot2_f32_bf16 v99, v65, v9, v99
  v_dot2_f32_bf16 v100, v66, v8, v100
  v_dot2_f32_bf16 v101, v66, v9, v101
  v_dot2_f32_bf16 v102, v67, v8, v102
  v_dot2_f32_bf16 v103, v67, v9, v103
  s_waitcnt vmcnt(0)
  v_dot2_f32_bf16 v96, v68, v8, v96
  v_dot2_f32_bf16 v97, v68, v9, v97
  v_dot2_f32_bf16 v98, v69, v8, v98
  v_dot2_f32_bf16 v99, v69, v9, v99
  v_dot2_f32_bf16 v100, v70, v8, v100
  v_dot2_f32_bf16 v101, v70, v9, v101
  v_dot2_f32_bf16 v102, v71, v8, v102
  v_dot2_f32_bf16 v103, v71, v9, v103
  v_max3_u32 v108, v40, v42, v44
  v_max3_u32 v108, v108, v46, v48
  v_max3_u32 v108, v108, v50, v52
  v_max3_u32 v108, v108, v54, v56
  v_max3_u32 v108, v108, v58, v60
  v_max3_u32 v108, v108, v62, v64
  v_max3_u32 v108, v108, v66, v68
  v_max_u32 v108, v108, v70
  v_cmp_eq_u32 vcc, -1, v108
  s_add_u32 s56, s56, 1
  s_cmp_ge_u32 s56, 200000
  s_cbranch_scc1 L_dpd_10
  s_cmp_lg_u64 vcc, 0
  s_cbranch_scc1 L_dp_9
L_dpd_10:
  s_branch L_sb_8
L_sr_11:
  s_mov_b32 s56, 0
L_dp_13:
  buffer_load_dwordx4 v[216:219], v4, s[44:47], s62 offen offset:0 sc1
  buffer_load_dwordx4 v[220:223], v4, s[44:47], s63 offen offset:0 sc1
  buffer_load_dwordx4 v[224:227], v4, s[44:47], s62 offen offset:1024 sc1
  buffer_load_dwordx4 v[228:231], v4, s[44:47], s63 offen offset:1024 sc1
  buffer_load_dwordx4 v[232:235], v4, s[44:47], s62 offen offset:2048 sc1
  buffer_load_dwordx4 v[236:239], v4, s[44:47], s63 offen offset:2048 sc1
  buffer_load_dwordx4 v[240:243], v4, s[44:47], s62 offen offset:3072 sc1
  buffer_load_dwordx4 v[244:247], v4, s[44:47], s63 offen offset:3072 sc1
  s_waitcnt vmcnt(7)
  v_mfma_f32_16x16x32_bf16 v[72:75], v[112:115], v[216:219], 0
  v_mfma_f32_16x16x32_bf16 v[76:79], v[116:119], v[216:219], 0
  v_mfma_f32_16x16x32_bf16 v[80:83], v[120:123], v[216:219], 0
  v_mfma_f32_16x16x32_bf16 v[84:87], v[124:127], v[216:219], 0
  s_waitcnt vmcnt(6)
  v_mfma_f32_16x16x32_bf16 v[88:91], v[112:115], v[220:223], 0
  v_mfma_f32_16x16x32_bf16 v[92:95], v[116:119], v[220:223], 0
  v_mfma_f32_16x16x32_bf16 v[96:99], v[120:123], v[220:223], 0
  v_mfma_f32_16x16x32_bf16 v[100:103], v[124:127], v[220:223], 0
  s_waitcnt vmcnt(5)
  v_mfma_f32_16x16x32_bf16 v[72:75], v[128:131], v[224:227], v[72:75]
  v_mfma_f32_16x16x32_bf16 v[76:79], v[132:135], v[224:227], v[76:79]
  v_mfma_f32_16x16x32_bf16 v[80:83], v[136:139], v[224:227], v[80:83]
  v_mfma_f32_16x16x32_bf16 v[84:87], v[140:143], v[224:227], v[84:87]
  s_waitcnt vmcnt(4)
  v_mfma_f32_16x16x32_bf16 v[88:91], v[128:131], v[228:231], v[88:91]
  v_mfma_f32_16x16x32_bf16 v[92:95], v[132:135], v[228:231], v[92:95]
  v_mfma_f32_16x16x32_bf16 v[96:99], v[136:139], v[228:231], v[96:99]
  v_mfma_f32_16x16x32_bf16 v[100:103], v[140:143], v[228:231], v[100:103]
  s_waitcnt vmcnt(3)
  v_mfma_f32_16x16x32_bf16 v[72:75], v[144:147], v[232:235], v[72:75]
  v_mfma_f32_16x16x32_bf16 v[76:79], v[148:151], v[232:235], v[76:79]
  v_mfma_f32_16x16x32_bf16 v[80:83], v[152:155], v[232:235], v[80:83]
  v_mfma_f32_16x16x32_bf16 v[84:87], v[156:159], v[232:235], v[84:87]
  s_waitcnt vmcnt(2)
  v_mfma_f32_16x16x32_bf16 v[88:91], v[144:147], v[236:239], v[88:91]
  v_mfma_f32_16x16x32_bf16 v[92:95], v[148:151], v[236:239], v[92:95]
  v_mfma_f32_16x16x32_bf16 v[96:99], v[152:155], v[236:239], v[96:99]
  v_mfma_f32_16x16x32_bf16 v[100:103], v[156:159], v[236:239], v[100:103]
  s_waitcnt vmcnt(1)
  v_mfma_f32_16x16x32_bf16 v[72:75], v[160:163], v[240:243], v[72:75]
  v_mfma_f32_16x16x32_bf16 v[76:79], v[164:167], v[240:243], v[76:79]
  v_mfma_f32_16x16x32_bf16 v[80:83], v[168:171], v[240:243], v[80:83]
  v_mfma_f32_16x16x32_bf16 v[84:87], v[172:175], v[240:243], v[84:87]
  s_waitcnt vmcnt(0)
  v_mfma_f32_16x16x32_bf16 v[88:91], v[160:163], v[244:247], v[88:91]
  v_mfma_f32_16x16x32_bf16 v[92:95], v[164:167], v[244:247], v[92:95]
  v_mfma_f32_16x16x32_bf16 v[96:99], v[168:171], v[244:247], v[96:99]
  v_mfma_f32_16x16x32_bf16 v[100:103], v[172:175], v[244:247], v[100:103]
  v_max3_u32 v5, v216, v220, v224
  v_max3_u32 v5, v5, v228, v232
  v_max3_u32 v5, v5, v236, v240
  v_max_u32 v5, v5, v244
  v_cmp_eq_u32 vcc, -1, v5
  s_add_u32 s56, s56, 1
  s_cmp_ge_u32 s56, 200000
  s_cbranch_scc1 L_dpd_14
  s_cmp_lg_u64 vcc, 0
  s_cbranch_scc1 L_dp_13
L_dpd_14:
  s_branch L_sb_12
L_sr_15:
  s_mov_b32 s56, 0
L_dp_17:
  buffer_load_dword v188, v198, s[44:47], s62 offen offset:0 sc1
  buffer_load_dword v189, v198, s[44:47], s62 offen offset:1024 sc1
  buffer_load_dword v190, v198, s[44:47], s62 offen offset:2048 sc1
  buffer_load_dword v191, v198, s[44:47], s62 offen offset:3072 sc1
  buffer_load_dword v192, v198, s[44:47], s63 offen offset:0 sc1
  buffer_load_dword v193, v198, s[44:47], s63 offen offset:1024 sc1
  buffer_load_dword v194, v198, s[44:47], s63 offen offset:2048 sc1
  buffer_load_dword v195, v198, s[44:47], s63 offen offset:3072 sc1
  s_waitcnt vmcnt(0)
  v_max3_u32 v5, v188, v189, v190
  v_max3_u32 v5, v5, v191, v192
  v_max3_u32 v5, v5, v193, v194
  v_max_u32 v5, v5, v195
  v_cmp_eq_u32 vcc, -1, v5
  s_add_u32 s56, s56, 1
  s_cmp_ge_u32 s56, 200000
  s_cbranch_scc1 L_dpd_18
  s_cmp_lg_u64 vcc, 0
  s_cbranch_scc1 L_dp_17
L_dpd_18:
  s_branch L_sb_16
L_cr_21:
  s_mov_b32 s56, 0
L_cl_23:
  s_sleep 1
  ds_read_b32 v11, v243 offset:0
  s_waitcnt lgkmcnt(0)
  v_readfirstlane_b32 s55, v11
  s_add_u32 s56, s56, 1
  s_cmp_ge_u32 s56, 1600000
  s_cbranch_scc1 L_cb_22
  s_cmp_lt_u32 s55, 8
  s_cbranch_scc1 L_cl_23
  s_branch L_cb_22
L_cr_24:
  s_mov_b32 s56, 0
L_cl_26:
  s_sleep 1
  ds_read_b32 v11, v243 offset:4
  s_waitcnt lgkmcnt(0)
  v_readfirstlane_b32 s55, v11
  s_add_u32 s56, s56, 1
  s_cmp_ge_u32 s56, 1600000
  s_cbranch_scc1 L_cb_25
  s_cmp_lt_u32 s55, 8
  s_cbranch_scc1 L_cl_26
  s_branch L_cb_25
L_cr_27:
  s_mov_b32 s56, 0
L_cl_29:
  s_sleep 1
  ds_read_b32 v11, v243 offset:8
  s_waitcnt lgkmcnt(0)
  v_readfirstlane_b32 s55, v11
  s_add_u32 s56, s56, 1
  s_cmp_ge_u32 s56, 1600000
  s_cbranch_scc1 L_cb_28
  s_cmp_lt_u32 s55, 8
  s_cbranch_scc1 L_cl_29
  s_branch L_cb_28
L_cr_30:
  s_mov_b32 s56, 0
L_cl_32:
  s_sleep 1
  ds_read_b32 v11, v243 offset:16
  s_waitcnt lgkmcnt(0)
  v_readfirstlane_b32 s55, v11
  s_add_u32 s56, s56, 1
  s_cmp_ge_u32 s56, 1600000
  s_cbranch_scc1 L_cb_31
  s_cmp_lt_u32 s55, 8
  s_cbranch_scc1 L_cl_32
  s_branch L_cb_31
L_hr_33:
  s_mov_b32 s56, 0
L_dp_35:
  s_add_u32 s53, s89, 0
  buffer_load_dwordx4 v[16:19], v4, s[44:47], s53 offen offset:0 sc1
  buffer_load_dwordx4 v[20:23], v4, s[44:47], s53 offen offset:1024 sc1
  buffer_load_dwordx4 v[24:27], v4, s[44:47], s53 offen offset:2048 sc1
  buffer_load_dwordx4 v[28:31], v4, s[44:47], s53 offen offset:3072 sc1
  s_add_u32 s53, s89, 4096
  buffer_load_dwordx4 v[32:35], v4, s[44:47], s53 offen offset:0 sc1
  buffer_load_dwordx4 v[36:39], v4, s[44:47], s53 offen offset:1024 sc1
  buffer_load_dwordx4 v[40:43], v4, s[44:47], s53 offen offset:2048 sc1
  buffer_load_dwordx4 v[44:47], v4, s[44:47], s53 offen offset:3072 sc1
  s_add_u32 s53, s89, 8192
  buffer_load_dwordx4 v[48:51], v4, s[44:47], s53 offen offset:0 sc1
  buffer_load_dwordx4 v[52:55], v4, s[44:47], s53 offen offset:1024 sc1
  buffer_load_dwordx4 v[56:59], v4, s[44:47], s53 offen offset:2048 sc1
  buffer_load_dwordx4 v[60:63], v4, s[44:47], s53 offen offset:3072 sc1
  s_add_u32 s53, s89, 12288
  buffer_load_dwordx4 v[64:67], v4, s[44:47], s53 offen offset:0 sc1
  buffer_load_dwordx4 v[68:71], v4, s[44:47], s53 offen offset:1024 sc1
  buffer_load_dwordx4 v[72:75], v4, s[44:47], s53 offen offset:2048 sc1
  buffer_load_dwordx4 v[76:79], v4, s[44:47], s53 offen offset:3072 sc1
  s_add_u32 s53, s89, 16384
  buffer_load_dwordx4 v[80:83], v4, s[44:47], s53 offen offset:0 sc1
  buffer_load_dwordx4 v[84:87], v4, s[44:47], s53 offen offset:1024 sc1
  buffer_load_dwordx4 v[88:91], v4, s[44:47], s53 offen offset:2048 sc1
  buffer_load_dwordx4 v[92:95], v4, s[44:47], s53 offen offset:3072 sc1
  s_add_u32 s53, s89, 20480
  buffer_load_dwordx4 v[96:99], v4, s[44:47], s53 offen offset:0 sc1
  buffer_load_dwordx4 v[100:103], v4, s[44:47], s53 offen offset:1024 sc1
  buffer_load_dwordx4 v[104:107], v4, s[44:47], s53 offen offset:2048 sc1
  buffer_load_dwordx4 v[108:111], v4, s[44:47], s53 offen offset:3072 sc1
  s_add_u32 s53, s89, 24576
  buffer_load_dwordx4 v[112:115], v4, s[44:47], s53 offen offset:0 sc1
  buffer_load_dwordx4 v[116:119], v4, s[44:47], s53 offen offset:1024 sc1
  buffer_load_dwordx4 v[120:123], v4, s[44:47], s53 offen offset:2048 sc1
  buffer_load_dwordx4 v[124:127], v4, s[44:47], s53 offen offset:3072 sc1
  s_waitcnt vmcnt(0)
  v_max3_u32 v6, v16, v20, v24
  v_max3_u32 v6, v6, v28, v32
  v_max3_u32 v6, v6, v36, v40
  v_max3_u32 v6, v6, v44, v48
  v_max3_u32 v6, v6, v52, v56
  v_max3_u32 v6, v6, v60, v64
  v_max3_u32 v6, v6, v68, v72
  v_max3_u32 v6, v6, v76, v80
  v_max3_u32 v6, v6, v84, v88
  v_max3_u32 v6, v6, v92, v96
  v_max3_u32 v6, v6, v100, v104
  v_max3_u32 v6, v6, v108, v112
  v_max3_u32 v6, v6, v116, v120
  v_max_u32 v6, v6, v124
  v_cmp_eq_u32 vcc, -1, v6
  s_add_u32 s56, s56, 1
  s_cmp_ge_u32 s56, 200000
  s_cbranch_scc1 L_dpd_36
  s_cmp_lg_u64 vcc, 0
  s_cbranch_scc1 L_dp_35
L_dpd_36:
  s_branch L_hb_34
L_hr_37:
  s_mov_b32 s56, 0
L_dp_39:
  s_add_u32 s53, s89, 4096
  buffer_load_dwordx4 v[32:35], v4, s[44:47], s53 offen offset:0 sc1
  buffer_load_dwordx4 v[36:39], v4, s[44:47], s53 offen offset:1024 sc1
  buffer_load_dwordx4 v[40:43], v4, s[44:47], s53 offen offset:2048 sc1
  buffer_load_dwordx4 v[44:47], v4, s[44:47], s53 offen offset:3072 sc1
  s_add_u32 s53, s89, 8192
  buffer_load_dwordx4 v[48:51], v4, s[44:47], s53 offen offset:0 sc1
  buffer_load_dwordx4 v[52:55], v4, s[44:47], s53 offen offset:1024 sc1
  buffer_load_dwordx4 v[56:59], v4, s[44:47], s53 offen offset:2048 sc1
  buffer_load_dwordx4 v[60:63], v4, s[44:47], s53 offen offset:3072 sc1
  s_add_u32 s53, s89, 12288
  buffer_load_dwordx4 v[64:67], v4, s[44:47], s53 offen offset:0 sc1
  buffer_load_dwordx4 v[68:71], v4, s[44:47], s53 offen offset:1024 sc1
  buffer_load_dwordx4 v[72:75], v4, s[44:47], s53 offen offset:2048 sc1
  buffer_load_dwordx4 v[76:79], v4, s[44:47], s53 offen offset:3072 sc1
  s_add_u32 s53, s89, 16384
  buffer_load_dwordx4 v[80:83], v4, s[44:47], s53 offen offset:0 sc1
  buffer_load_dwordx4 v[84:87], v4, s[44:47], s53 offen offset:1024 sc1
  buffer_load_dwordx4 v[88:91], v4, s[44:47], s53 offen offset:2048 sc1
  buffer_load_dwordx4 v[92:95], v4, s[44:47], s53 offen offset:3072 sc1
  s_add_u32 s53, s89, 20480
  buffer_load_dwordx4 v[96:99], v4, s[44:47], s53 offen offset:0 sc1
  buffer_load_dwordx4 v[100:103], v4, s[44:47], s53 offen offset:1024 sc1
  buffer_load_dwordx4 v[104:107], v4, s[44:47], s53 offen offset:2048 sc1
  buffer_load_dwordx4 v[108:111], v4, s[44:47], s53 offen offset:3072 sc1
  s_add_u32 s53, s89, 24576
  buffer_load_dwordx4 v[112:115], v4, s[44:47], s53 offen offset:0 sc1
  buffer_load_dwordx4 v[116:119], v4, s[44:47], s53 offen offset:1024 sc1
  buffer_load_dwordx4 v[120:123], v4, s[44:47], s53 offen offset:2048 sc1
  buffer_load_dwordx4 v[124:127], v4, s[44:47], s53 offen offset:3072 sc1
  s_waitcnt vmcnt(0)
  v_max3_u32 v6, v32, v36, v40
  v_max3_u32 v6, v6, v44, v48
  v_max3_u32 v6, v6, v52, v56
  v_max3_u32 v6, v6, v60, v64
  v_max3_u32 v6, v6, v68, v72
  v_max3_u32 v6, v6, v76, v80
  v_max3_u32 v6, v6, v84, v88
  v_max3_u32 v6, v6, v92, v96
  v_max3_u32 v6, v6, v100, v104
  v_max3_u32 v6, v6, v108, v112
  v_max3_u32 v6, v6, v116, v120
  v_max_u32 v6, v6, v124
  v_cmp_eq_u32 vcc, -1, v6
  s_add_u32 s56, s56, 1
  s_cmp_ge_u32 s56, 200000
  s_cbranch_scc1 L_dpd_40
  s_cmp_lg_u64 vcc, 0
  s_cbranch_scc1 L_dp_39
L_dpd_40:
  s_branch L_hb_38
L_hr_41:
  s_mov_b32 s56, 0
L_dp_43:
  s_add_u32 s53, s89, 8192
  buffer_load_dwordx4 v[48:51], v4, s[44:47], s53 offen offset:0 sc1
  buffer_load_dwordx4 v[52:55], v4, s[44:47], s53 offen offset:1024 sc1
  buffer_load_dwordx4 v[56:59], v4, s[44:47], s53 offen offset:2048 sc1
  buffer_load_dwordx4 v[60:63], v4, s[44:47], s53 offen offset:3072 sc1
  s_add_u32 s53, s89, 12288
  buffer_load_dwordx4 v[64:67], v4, s[44:47], s53 offen offset:0 sc1
  buffer_load_dwordx4 v[68:71], v4, s[44:47], s53 offen offset:1024 sc1
  buffer_load_dwordx4 v[72:75], v4, s[44:47], s53 offen offset:2048 sc1
  buffer_load_dwordx4 v[76:79], v4, s[44:47], s53 offen offset:3072 sc1
  s_add_u32 s53, s89, 16384
  buffer_load_dwordx4 v[80:83], v4, s[44:47], s53 offen offset:0 sc1
  buffer_load_dwordx4 v[84:87], v4, s[44:47], s53 offen offset:1024 sc1
  buffer_load_dwordx4 v[88:91], v4, s[44:47], s53 offen offset:2048 sc1
  buffer_load_dwordx4 v[92:95], v4, s[44:47], s53 offen offset:3072 sc1
  s_add_u32 s53, s89, 20480
  buffer_load_dwordx4 v[96:99], v4, s[44:47], s53 offen offset:0 sc1
  buffer_load_dwordx4 v[100:103], v4, s[44:47], s53 offen offset:1024 sc1
  buffer_load_dwordx4 v[104:107], v4, s[44:47], s53 offen offset:2048 sc1
  buffer_load_dwordx4 v[108:111], v4, s[44:47], s53 offen offset:3072 sc1
  s_add_u32 s53, s89, 24576
  buffer_load_dwordx4 v[112:115], v4, s[44:47], s53 offen offset:0 sc1
  buffer_load_dwordx4 v[116:119], v4, s[44:47], s53 offen offset:1024 sc1
  buffer_load_dwordx4 v[120:123], v4, s[44:47], s53 offen offset:2048 sc1
  buffer_load_dwordx4 v[124:127], v4, s[44:47], s53 offen offset:3072 sc1
  s_waitcnt vmcnt(0)
  v_max3_u32 v6, v48, v52, v56
  v_max3_u32 v6, v6, v60, v64
  v_max3_u32 v6, v6, v68, v72
  v_max3_u32 v6, v6, v76, v80
  v_max3_u32 v6, v6, v84, v88
  v_max3_u32 v6, v6, v92, v96
  v_max3_u32 v6, v6, v100, v104
  v_max3_u32 v6, v6, v108, v112
  v_max3_u32 v6, v6, v116, v120
  v_max_u32 v6, v6, v124
  v_cmp_eq_u32 vcc, -1, v6
  s_add_u32 s56, s56, 1
  s_cmp_ge_u32 s56, 200000
  s_cbranch_scc1 L_dpd_44
  s_cmp_lg_u64 vcc, 0
  s_cbranch_scc1 L_dp_43
L_dpd_44:
  s_branch L_hb_42
L_hr_45:
  s_mov_b32 s56, 0
L_dp_47:
  s_add_u32 s53, s89, 12288
  buffer_load_dwordx4 v[64:67], v4, s[44:47], s53 offen offset:0 sc1
  buffer_load_dwordx4 v[68:71], v4, s[44:47], s53 offen offset:1024 sc1
  buffer_load_dwordx4 v[72:75], v4, s[44:47], s53 offen offset:2048 sc1
  buffer_load_dwordx4 v[76:79], v4, s[44:47], s53 offen offset:3072 sc1
  s_add_u32 s53, s89, 16384
  buffer_load_dwordx4 v[80:83], v4, s[44:47], s53 offen offset:0 sc1
  buffer_load_dwordx4 v[84:87], v4, s[44:47], s53 offen offset:1024 sc1
  buffer_load_dwordx4 v[88:91], v4, s[44:47], s53 offen offset:2048 sc1
  buffer_load_dwordx4 v[92:95], v4, s[44:47], s53 offen offset:3072 sc1
  s_add_u32 s53, s89, 20480
  buffer_load_dwordx4 v[96:99], v4, s[44:47], s53 offen offset:0 sc1
  buffer_load_dwordx4 v[100:103], v4, s[44:47], s53 offen offset:1024 sc1
  buffer_load_dwordx4 v[104:107], v4, s[44:47], s53 offen offset:2048 sc1
  buffer_load_dwordx4 v[108:111], v4, s[44:47], s53 offen offset:3072 sc1
  s_add_u32 s53, s89, 24576
  buffer_load_dwordx4 v[112:115], v4, s[44:47], s53 offen offset:0 sc1
  buffer_load_dwordx4 v[116:119], v4, s[44:47], s53 offen offset:1024 sc1
  buffer_load_dwordx4 v[120:123], v4, s[44:47], s53 offen offset:2048 sc1
  buffer_load_dwordx4 v[124:127], v4, s[44:47], s53 offen offset:3072 sc1
  s_waitcnt vmcnt(0)
  v_max3_u32 v6, v64, v68, v72
  v_max3_u32 v6, v6, v76, v80
  v_max3_u32 v6, v6, v84, v88
  v_max3_u32 v6, v6, v92, v96
  v_max3_u32 v6, v6, v100, v104
  v_max3_u32 v6, v6, v108, v112
  v_max3_u32 v6, v6, v116, v120
  v_max_u32 v6, v6, v124
  v_cmp_eq_u32 vcc, -1, v6
  s_add_u32 s56, s56, 1
  s_cmp_ge_u32 s56, 200000
  s_cbranch_scc1 L_dpd_48
  s_cmp_lg_u64 vcc, 0
  s_cbranch_scc1 L_dp_47
L_dpd_48:
  s_branch L_hb_46
L_hr_49:
  s_mov_b32 s56, 0
L_dp_51:
  s_add_u32 s53, s89, 16384
  buffer_load_dwordx4 v[80:83], v4, s[44:47], s53 offen offset:0 sc1
  buffer_load_dwordx4 v[84:87], v4, s[44:47], s53 offen offset:1024 sc1
  buffer_load_dwordx4 v[88:91], v4, s[44:47], s53 offen offset:2048 sc1
  buffer_load_dwordx4 v[92:95], v4, s[44:47], s53 offen offset:3072 sc1
  s_add_u32 s53, s89, 20480
  buffer_load_dwordx4 v[96:99], v4, s[44:47], s53 offen offset:0 sc1
  buffer_load_dwordx4 v[100:103], v4, s[44:47], s53 offen offset:1024 sc1
  buffer_load_dwordx4 v[104:107], v4, s[44:47], s53 offen offset:2048 sc1
  buffer_load_dwordx4 v[108:111], v4, s[44:47], s53 offen offset:3072 sc1
  s_add_u32 s53, s89, 24576
  buffer_load_dwordx4 v[112:115], v4, s[44:47], s53 offen offset:0 sc1
  buffer_load_dwordx4 v[116:119], v4, s[44:47], s53 offen offset:1024 sc1
  buffer_load_dwordx4 v[120:123], v4, s[44:47], s53 offen offset:2048 sc1
  buffer_load_dwordx4 v[124:127], v4, s[44:47], s53 offen offset:3072 sc1
  s_waitcnt vmcnt(0)
  v_max3_u32 v6, v80, v84, v88
  v_max3_u32 v6, v6, v92, v96
  v_max3_u32 v6, v6, v100, v104
  v_max3_u32 v6, v6, v108, v112
  v_max3_u32 v6, v6, v116, v120
  v_max_u32 v6, v6, v124
  v_cmp_eq_u32 vcc, -1, v6
  s_add_u32 s56, s56, 1
  s_cmp_ge_u32 s56, 200000
  s_cbranch_scc1 L_dpd_52
  s_cmp_lg_u64 vcc, 0
  s_cbranch_scc1 L_dp_51
L_dpd_52:
  s_branch L_hb_50
L_hr_53:
  s_mov_b32 s56, 0
L_dp_55:
  s_add_u32 s53, s89, 20480
  buffer_load_dwordx4 v[96:99], v4, s[44:47], s53 offen offset:0 sc1
  buffer_load_dwordx4 v[100:103], v4, s[44:47], s53 offen offset:1024 sc1
  buffer_load_dwordx4 v[104:107], v4, s[44:47], s53 offen offset:2048 sc1
  buffer_load_dwordx4 v[108:111], v4, s[44:47], s53 offen offset:3072 sc1
  s_add_u32 s53, s89, 24576
  buffer_load_dwordx4 v[112:115], v4, s[44:47], s53 offen offset:0 sc1
  buffer_load_dwordx4 v[116:119], v4, s[44:47], s53 offen offset:1024 sc1
  buffer_load_dwordx4 v[120:123], v4, s[44:47], s53 offen offset:2048 sc1
  buffer_load_dwordx4 v[124:127], v4, s[44:47], s53 offen offset:3072 sc1
  s_waitcnt vmcnt(0)
  v_max3_u32 v6, v96, v100, v104
  v_max3_u32 v6, v6, v108, v112
  v_max3_u32 v6, v6, v116, v120
  v_max_u32 v6, v6, v124
  v_cmp_eq_u32 vcc, -1, v6
  s_add_u32 s56, s56, 1
  s_cmp_ge_u32 s56, 200000
  s_cbranch_scc1 L_dpd_56
  s_cmp_lg_u64 vcc, 0
  s_cbranch_scc1 L_dp_55
L_dpd_56:
  s_branch L_hb_54
L_hr_57:
  s_mov_b32 s56, 0
L_dp_59:
  s_add_u32 s53, s89, 24576
  buffer_load_dwordx4 v[112:115], v4, s[44:47], s53 offen offset:0 sc1
  buffer_load_dwordx4 v[116:119], v4, s[44:47], s53 offen offset:1024 sc1
  buffer_load_dwordx4 v[120:123], v4, s[44:47], s53 offen offset:2048 sc1
  buffer_load_dwordx4 v[124:127], v4, s[44:47], s53 offen offset:3072 sc1
  s_waitcnt vmcnt(0)
  v_max3_u32 v6, v112, v116, v120
  v_max_u32 v6, v6, v124
  v_cmp_eq_u32 vcc, -1, v6
  s_add_u32 s56, s56, 1
  s_cmp_ge_u32 s56, 200000
  s_cbranch_scc1 L_dpd_60
  s_cmp_lg_u64 vcc, 0
  s_cbranch_scc1 L_dp_59
L_dpd_60:
  s_branch L_hb_58
L_code_end:
.fill 64, 4, 0xbf800000
.section .rodata,"a"
.p2align 6
.amdhsa_kernel sequential_preLN__linear_kernel_hedgehog__glu_gated_geglu__prompt_kernel
  .amdhsa_next_free_vgpr 256
  .amdhsa_next_free_sgpr 102
  .amdhsa_accum_offset 256
  .amdhsa_group_segment_fixed_size 0
  .amdhsa_kernarg_size 88
  .amdhsa_user_sgpr_count 2
  .amdhsa_user_sgpr_kernarg_segment_ptr 1
  .amdhsa_system_sgpr_workgroup_id_x 1
.end_amdhsa_kernel
```
